```python
import torch

def _softmax(x, axis=-1):
    return torch.softmax(x, dim=axis)
def _gelu(x):
    return torch.nn.functional.gelu(x, approximate="tanh")
def _silu(x):
    return torch.nn.functional.silu(x)
def _sigmoid(x):
    return torch.sigmoid(x)
def _layernorm(x, axis=-1, eps=1e-5):
    m = x.mean(dim=axis, keepdim=True)
    v = x.var(dim=axis, keepdim=True, unbiased=False)
    return (x - m) / torch.sqrt(v + eps)
def _scatter_add(tgt, idx, src, axis=0):
    return tgt.clone().index_add_(axis, idx, src)
def _segment_sum(src, seg, n):
    out = torch.zeros((n,) + src.shape[1:], dtype=src.dtype)
    return out.index_add_(0, seg, src)
def _pad(x, pw):
    flat = tuple(v for pair in reversed(pw) for v in pair)
    return torch.nn.functional.pad(x, flat)

kernel_name = 'standalone__dense_activation_mish__prompt'

def setup_inputs():

    _w = (lambda a: (lambda t: t.to(torch.bfloat16) if t.is_floating_point() else t)(torch.as_tensor(a)))
    B, S, D, F = 1, 2048, 512, 1792
    return {
        "x": _w((lambda *s: torch.randn(*s, dtype=torch.bfloat16) * 0.05)(B, S, D)),
        "w1": _w((lambda *s: torch.randn(*s, dtype=torch.bfloat16) * 3.2)(D, F) * (D ** -0.5)),
        "b1": _w((lambda *s: torch.randn(*s, dtype=torch.bfloat16) * 0.05)(F)),
        "w2": _w((lambda *s: torch.randn(*s, dtype=torch.bfloat16) * 0.05)(F, D) * (F ** -0.5)),
    }

def reference(x, w1, b1, w2):
    h = torch.einsum("bsd,df->bsf", x, w1) + b1
    sp = torch.log1p(torch.exp(-torch.abs(h))) + torch.where(h > 0, h, torch.zeros_like(h))
    act = h * torch.tanh(sp)
    return torch.einsum("bsf,fd->bsd", act, w2)
```

```asm
; @launch grid=(256,1,1) block=(512,1,1) lds=163840
.amdgcn_target "amdgcn-amd-amdhsa--gfx950"
.text
.globl standalone__dense_activation_mish__prompt_kernel
.p2align 8
.type standalone__dense_activation_mish__prompt_kernel,@function
standalone__dense_activation_mish__prompt_kernel:
    s_load_dwordx2 s[20:21], s[0:1], 0
    s_load_dwordx2 s[24:25], s[0:1], 8
    s_load_dwordx4 s[8:11], s[0:1], 16
    s_load_dwordx2 s[12:13], s[0:1], 32
    s_load_dwordx2 s[16:17], s[0:1], 48
    v_lshrrev_b32 v1, 6, v0
    s_cmp_ge_u32 s2, 256
    s_cbranch_scc1 L_end
    v_readfirstlane_b32 s48, v1
    s_and_b32 s44, s2, 3
    s_lshr_b32 s45, s2, 2
    s_xor_b32 s45, s45, s2
    s_and_b32 s45, s45, 1
    v_and_b32 v2, 63, v0
    s_lshr_b32 s46, s2, 6
    s_bfe_u32 s47, s2, 0x30003
    s_and_b32 s49, s48, 3
    s_cmp_lt_u32 s48, 4
    s_cbranch_scc0 L_cwave
    v_lshrrev_b32 v3, 3, v2
    v_and_b32 v4, 7, v2
    v_lshrrev_b32 v5, 1, v3
    v_lshlrev_b32 v8, 10, v3
    s_cmp_eq_u32 s47, 7
    s_cbranch_scc1 L_lsetup0
    v_xor_b32 v6, v4, v5
    s_lshl2_add_u32 s54, s44, s46
    s_lshl2_add_u32 s54, s54, s49
    s_lshl_b32 s54, s54, 15
    v_lshl_add_u32 v6, v6, 4, v8
    v_add_u32 v240, s54, v6
    v_xor_b32 v241, 64, v240
    v_add_u32 v242, 14336, v240
    v_add_u32 v243, 21504, v241
    v_add_u32 v241, 7168, v241
    s_and_b32 s60, s44, 2
    s_xor_b32 s54, s46, s47
    s_and_b32 s54, s54, 1
    s_lshl2_add_u32 s60, s54, s60
    s_lshl_b32 s59, s49, 12
    s_mov_b32 s22, 2097152
    s_mov_b32 s23, 0x20000
    s_mov_b32 s26, 1835008
    s_mov_b32 s27, 0x20000
    v_lshrrev_b32 v3, 4, v2
    v_and_b32 v6, 15, v2
    v_lshlrev_b32 v7, 1, v3
    v_xor_b32 v6, v6, v7
    v_mul_u32_u24 v3, 3584, v3
    s_mul_i32 s54, s49, 224
    s_mul_i32 s55, s45, 7
    s_add_u32 s55, s55, s47
    s_add_u32 s54, s54, s55
    s_lshl_b32 s54, s54, 8
    v_lshl_add_u32 v6, v6, 4, v3
    v_add_u32 v244, s54, v6
    v_xor_b32 v246, 128, v244
    v_add_u32 v245, 13312, v244
    v_add_u32 v247, 39936, v246
    v_add_u32 v246, 26624, v246
    s_lshl_b32 s54, s60, 7
    s_mov_b32 m0, s59
    s_mul_i32 s55, s60, 229376
    s_waitcnt lgkmcnt(0)
    buffer_load_dwordx4 v240, s[20:23], s54 offen offset:0  lds
    buffer_load_dwordx4 v241, s[20:23], s54 offen offset:1024  lds
    buffer_load_dwordx4 v242, s[20:23], s54 offen offset:2048  lds
    buffer_load_dwordx4 v243, s[20:23], s54 offen offset:3072  lds
    s_add_u32 m0, s59, 16384
    s_add_u32 s60, s60, 1
    buffer_load_dwordx4 v244, s[24:27], s55 offen offset:0  lds
    buffer_load_dwordx4 v245, s[24:27], s55 offen offset:1024  lds
    buffer_load_dwordx4 v246, s[24:27], s55 offen offset:2048  lds
    buffer_load_dwordx4 v247, s[24:27], s55 offen offset:3072  lds
    s_and_b32 s60, s60, 7
    s_add_u32 s59, s59, 32768
    s_cmp_ge_u32 s59, 163840
    s_cselect_b32 s54, 163840, 0
    s_sub_u32 s59, s59, s54
    s_lshl_b32 s54, s60, 7
    s_mov_b32 m0, s59
    s_mul_i32 s55, s60, 229376
    buffer_load_dwordx4 v240, s[20:23], s54 offen offset:0  lds
    buffer_load_dwordx4 v241, s[20:23], s54 offen offset:1024  lds
    buffer_load_dwordx4 v242, s[20:23], s54 offen offset:2048  lds
    buffer_load_dwordx4 v243, s[20:23], s54 offen offset:3072  lds
L_lsetup0:
    s_lshl_b32 s50, s45, 2
    s_add_u32 s50, s50, s46
    s_and_b32 s56, s2, 7
    s_lshl_b32 s56, s56, 2
    s_lshr_b32 s56, 0x10210210, s56
    s_cmp_ge_u32 s46, 2
    s_cselect_b32 s56, 7, s56
    s_lshl_b32 s57, s46, 2
    s_add_u32 s56, s56, s57
    s_add_u32 s51, s56, s47
    s_add_u32 s51, s51, 1
    s_and_b32 s51, s51, 7
    v_lshlrev_b32 v5, 1, v5
    v_xor_b32 v5, v4, v5
    s_mul_i32 s56, s49, 3584
    s_add_u32 s56, s56, s51
    s_lshl_b32 s56, s56, 7
    v_lshl_add_u32 v5, v5, 4, v8
    v_add_u32 v10, s56, v5
    v_add_u32 v11, 7168, v10
    v_add_u32 v12, 14336, v10
    v_add_u32 v13, 21504, v10
    s_lshl_b32 s61, s49, 13
    s_mov_b32 s30, 1835008
    s_mov_b32 s31, 0x20000
    s_waitcnt lgkmcnt(0)
    s_mov_b64 s[28:29], s[10:11]
    s_lshl_b32 s4, s44, 14
    s_mul_i32 s56, s45, 24576
    s_add_u32 s4, s4, s56
    s_cmp_ge_u32 s4, 57344
    s_cselect_b32 s56, 57344, 0
    s_sub_u32 s4, s4, s56
    s_add_u32 s5, s4, 8192
    s_cmp_eq_u32 s5, 57344
    s_cselect_b32 s5, 0, s5
    s_add_u32 s6, s5, 8192
    s_cmp_eq_u32 s6, 57344
    s_cselect_b32 s6, 0, s6
    s_add_u32 s7, s6, 8192
    s_cmp_eq_u32 s7, 57344
    s_cselect_b32 s7, 0, s7
    s_add_u32 s8, s7, 8192
    s_cmp_eq_u32 s8, 57344
    s_cselect_b32 s8, 0, s8
    s_add_u32 s9, s8, 8192
    s_cmp_eq_u32 s9, 57344
    s_cselect_b32 s9, 0, s9
    s_add_u32 s10, s9, 8192
    s_cmp_eq_u32 s10, 57344
    s_cselect_b32 s10, 0, s10
    s_cmp_lg_u32 s47, 7
    s_cbranch_scc1 L_lsetup1
    s_lshl_b32 s54, s4, 3
    s_add_u32 m0, s61, 98304
    s_nop 0
    buffer_load_dwordx4 v10, s[28:31], s54 offen offset:0  lds
    buffer_load_dwordx4 v11, s[28:31], s54 offen offset:1024  lds
    buffer_load_dwordx4 v12, s[28:31], s54 offen offset:2048  lds
    buffer_load_dwordx4 v13, s[28:31], s54 offen offset:3072  lds
    s_lshl_b32 s54, s5, 3
    s_add_u32 m0, s61, 102400
    s_nop 0
    buffer_load_dwordx4 v10, s[28:31], s54 offen offset:0  lds
    buffer_load_dwordx4 v11, s[28:31], s54 offen offset:1024  lds
    buffer_load_dwordx4 v12, s[28:31], s54 offen offset:2048  lds
    buffer_load_dwordx4 v13, s[28:31], s54 offen offset:3072  lds
L_lsetup1:
    s_lshl_b32 s56, s44, 17
    s_add_u32 s56, s56, 8388608
    s_add_u32 s62, s16, s56
    s_addc_u32 s63, s17, 0
    s_load_dwordx2 s[52:53], s[62:63], 0
    s_mov_b64 s[32:33], s[16:17]
    s_mov_b32 s34, 16777216
    s_mov_b32 s35, 0x20000
    v_lshrrev_b32 v3, 2, v2
    v_lshlrev_b32 v3, 7, v3
    v_bfe_u32 v4, v2, 3, 2
    v_lshl_add_u32 v3, v4, 5, v3
    v_and_b32 v4, 3, v2
    v_lshl_add_u32 v3, v4, 3, v3
    v_add_u32 v20, s61, v3
    v_xor_b32 v21, 32, v20
    v_xor_b32 v22, 64, v20
    v_xor_b32 v23, 96, v20
    v_add_u32 v24, 0x10000, v20
    v_add_u32 v25, 0x10000, v21
    v_add_u32 v26, 0x10000, v22
    v_add_u32 v27, 0x10000, v23
    v_add_u32 v28, 0x20000, v20
    v_add_u32 v29, 0x20000, v21
    v_add_u32 v30, 0x20000, v22
    v_add_u32 v31, 0x20000, v23
    s_lshl2_add_u32 s57, s50, s49
    s_mul_i32 s56, s57, 896
    s_add_u32 s18, s62, s56
    s_addc_u32 s19, s63, 0
    v_min_u32 v3, 6, v2
    s_add_u32 s56, s56, 0x8000
    v_lshl_add_u32 v8, v3, 7, s56
    v_add_u32 v16, 0x8000, v8
    s_lshl_b32 s56, s44, 5
    s_add_u32 s57, s57, s56
    s_mul_i32 s57, s57, 57344
    v_lshl_add_u32 v9, v2, 4, s57
    v_add_u32 v1, 4096, v9
    v_lshrrev_b32 v3, 5, v2
    v_lshlrev_b32 v3, 2, v3
    v_xor_b32 v3, v3, v2
    v_lshl_add_u32 v4, v3, 4, s61
    v_xor_b32 v5, 128, v4
    s_mov_b32 s58, 0
    s_cmp_eq_u32 s47, 7
    s_cbranch_scc1 L_lq2
L_lloop:
    s_add_u32 m0, s59, 16384
    s_add_u32 s60, s60, 1
    buffer_load_dwordx4 v244, s[24:27], s55 offen offset:0  lds
    buffer_load_dwordx4 v245, s[24:27], s55 offen offset:1024  lds
    buffer_load_dwordx4 v246, s[24:27], s55 offen offset:2048  lds
    buffer_load_dwordx4 v247, s[24:27], s55 offen offset:3072  lds
    s_and_b32 s60, s60, 7
    s_add_u32 s59, s59, 32768
    s_cmp_ge_u32 s59, 163840
    s_cselect_b32 s54, 163840, 0
    s_sub_u32 s59, s59, s54
    s_waitcnt vmcnt(8) lgkmcnt(0)
    s_barrier
    s_lshl_b32 s54, s60, 7
    s_mov_b32 m0, s59
    s_mul_i32 s55, s60, 229376
    buffer_load_dwordx4 v240, s[20:23], s54 offen offset:0  lds
    buffer_load_dwordx4 v241, s[20:23], s54 offen offset:1024  lds
    buffer_load_dwordx4 v242, s[20:23], s54 offen offset:2048  lds
    buffer_load_dwordx4 v243, s[20:23], s54 offen offset:3072  lds
    s_add_u32 s58, s58, 1
    s_cmp_lt_u32 s58, 6
    s_cbranch_scc1 L_lloop
    s_add_u32 m0, s59, 16384
    s_add_u32 s60, s60, 1
    buffer_load_dwordx4 v244, s[24:27], s55 offen offset:0  lds
    buffer_load_dwordx4 v245, s[24:27], s55 offen offset:1024  lds
    buffer_load_dwordx4 v246, s[24:27], s55 offen offset:2048  lds
    buffer_load_dwordx4 v247, s[24:27], s55 offen offset:3072  lds
    s_and_b32 s60, s60, 7
    s_add_u32 s59, s59, 32768
    s_cmp_ge_u32 s59, 163840
    s_cselect_b32 s54, 163840, 0
    s_sub_u32 s59, s59, s54
    s_lshl_b32 s54, s4, 3
    s_add_u32 m0, s61, 98304
    s_nop 0
    buffer_load_dwordx4 v10, s[28:31], s54 offen offset:0  lds
    buffer_load_dwordx4 v11, s[28:31], s54 offen offset:1024  lds
    buffer_load_dwordx4 v12, s[28:31], s54 offen offset:2048  lds
    buffer_load_dwordx4 v13, s[28:31], s54 offen offset:3072  lds
    s_waitcnt vmcnt(12)
    s_barrier
    s_lshl_b32 s54, s5, 3
    s_add_u32 m0, s61, 102400
    s_nop 0
    buffer_load_dwordx4 v10, s[28:31], s54 offen offset:0  lds
    buffer_load_dwordx4 v11, s[28:31], s54 offen offset:1024  lds
    buffer_load_dwordx4 v12, s[28:31], s54 offen offset:2048  lds
    buffer_load_dwordx4 v13, s[28:31], s54 offen offset:3072  lds
    s_waitcnt vmcnt(8)
    s_barrier
L_lq2:
    s_lshl_b32 s54, s6, 3
    s_add_u32 m0, s61, 131072
    s_nop 0
    buffer_load_dwordx4 v10, s[28:31], s54 offen offset:0  lds
    buffer_load_dwordx4 v11, s[28:31], s54 offen offset:1024  lds
    buffer_load_dwordx4 v12, s[28:31], s54 offen offset:2048  lds
    buffer_load_dwordx4 v13, s[28:31], s54 offen offset:3072  lds
    s_lshl_b32 s54, s7, 3
    s_add_u32 m0, s61, 135168
    s_nop 0
    buffer_load_dwordx4 v10, s[28:31], s54 offen offset:0  lds
    buffer_load_dwordx4 v11, s[28:31], s54 offen offset:1024  lds
    buffer_load_dwordx4 v12, s[28:31], s54 offen offset:2048  lds
    buffer_load_dwordx4 v13, s[28:31], s54 offen offset:3072  lds
    s_waitcnt lgkmcnt(0)
    s_barrier
L_nob8:
    s_lshl_b32 s54, s8, 3
    s_add_u32 m0, s61, 0
    s_nop 0
    buffer_load_dwordx4 v10, s[28:31], s54 offen offset:0  lds
    buffer_load_dwordx4 v11, s[28:31], s54 offen offset:1024  lds
    buffer_load_dwordx4 v12, s[28:31], s54 offen offset:2048  lds
    buffer_load_dwordx4 v13, s[28:31], s54 offen offset:3072  lds
    s_lshl_b32 s54, s9, 3
    s_add_u32 m0, s61, 4096
    s_nop 0
    buffer_load_dwordx4 v10, s[28:31], s54 offen offset:0  lds
    buffer_load_dwordx4 v11, s[28:31], s54 offen offset:1024  lds
    buffer_load_dwordx4 v12, s[28:31], s54 offen offset:2048  lds
    buffer_load_dwordx4 v13, s[28:31], s54 offen offset:3072  lds
    s_lshl_b32 s54, s10, 3
    s_add_u32 m0, s61, 32768
    s_nop 0
    buffer_load_dwordx4 v10, s[28:31], s54 offen offset:0  lds
    buffer_load_dwordx4 v11, s[28:31], s54 offen offset:1024  lds
    buffer_load_dwordx4 v12, s[28:31], s54 offen offset:2048  lds
    buffer_load_dwordx4 v13, s[28:31], s54 offen offset:3072  lds
    s_cmp_lg_u32 s47, 7
    s_cbranch_scc1 L_sf0
    s_lshl_b32 s54, s4, 3
    s_add_u32 m0, s61, 36864
    s_add_u32 s54, s54, 32768
    buffer_load_dwordx4 v10, s[28:31], s54 offen offset:0  lds
    buffer_load_dwordx4 v11, s[28:31], s54 offen offset:1024  lds
    buffer_load_dwordx4 v12, s[28:31], s54 offen offset:2048  lds
    buffer_load_dwordx4 v13, s[28:31], s54 offen offset:3072  lds
    s_lshl_b32 s54, s5, 3
    s_add_u32 m0, s61, 65536
    s_add_u32 s54, s54, 32768
    buffer_load_dwordx4 v10, s[28:31], s54 offen offset:0  lds
    buffer_load_dwordx4 v11, s[28:31], s54 offen offset:1024  lds
    buffer_load_dwordx4 v12, s[28:31], s54 offen offset:2048  lds
    buffer_load_dwordx4 v13, s[28:31], s54 offen offset:3072  lds
    s_lshl_b32 s54, s6, 3
    s_add_u32 m0, s61, 69632
    s_add_u32 s54, s54, 32768
    buffer_load_dwordx4 v10, s[28:31], s54 offen offset:0  lds
    buffer_load_dwordx4 v11, s[28:31], s54 offen offset:1024  lds
    buffer_load_dwordx4 v12, s[28:31], s54 offen offset:2048  lds
    buffer_load_dwordx4 v13, s[28:31], s54 offen offset:3072  lds
    s_waitcnt vmcnt(16)
    s_branch L_sf1
L_sf0:
    s_waitcnt vmcnt(4)
L_sf1:
    ds_read_b64_tr_b16 v[32:33], v24 offset:32768
    ds_read_b64_tr_b16 v[34:35], v24 offset:34816
    ds_read_b64_tr_b16 v[36:37], v25 offset:32768
    ds_read_b64_tr_b16 v[38:39], v25 offset:34816
    ds_read_b64_tr_b16 v[40:41], v26 offset:32768
    ds_read_b64_tr_b16 v[42:43], v26 offset:34816
    ds_read_b64_tr_b16 v[44:45], v27 offset:32768
    ds_read_b64_tr_b16 v[46:47], v27 offset:34816
    ds_read_b64_tr_b16 v[48:49], v24 offset:36864
    ds_read_b64_tr_b16 v[50:51], v24 offset:38912
    ds_read_b64_tr_b16 v[52:53], v25 offset:36864
    ds_read_b64_tr_b16 v[54:55], v25 offset:38912
    ds_read_b64_tr_b16 v[56:57], v26 offset:36864
    ds_read_b64_tr_b16 v[58:59], v26 offset:38912
    ds_read_b64_tr_b16 v[60:61], v27 offset:36864
    ds_read_b64_tr_b16 v[62:63], v27 offset:38912
    ds_read_b64_tr_b16 v[64:65], v28 offset:0
    ds_read_b64_tr_b16 v[66:67], v28 offset:2048
    ds_read_b64_tr_b16 v[68:69], v29 offset:0
    ds_read_b64_tr_b16 v[70:71], v29 offset:2048
    ds_read_b64_tr_b16 v[72:73], v30 offset:0
    ds_read_b64_tr_b16 v[74:75], v30 offset:2048
    ds_read_b64_tr_b16 v[76:77], v31 offset:0
    ds_read_b64_tr_b16 v[78:79], v31 offset:2048
    ds_read_b64_tr_b16 v[80:81], v28 offset:4096
    ds_read_b64_tr_b16 v[82:83], v28 offset:6144
    ds_read_b64_tr_b16 v[84:85], v29 offset:4096
    ds_read_b64_tr_b16 v[86:87], v29 offset:6144
    ds_read_b64_tr_b16 v[88:89], v30 offset:4096
    ds_read_b64_tr_b16 v[90:91], v30 offset:6144
    ds_read_b64_tr_b16 v[92:93], v31 offset:4096
    ds_read_b64_tr_b16 v[94:95], v31 offset:6144
    ds_read_b64_tr_b16 v[160:161], v20 offset:0
    ds_read_b64_tr_b16 v[162:163], v20 offset:2048
    ds_read_b64_tr_b16 v[164:165], v21 offset:0
    ds_read_b64_tr_b16 v[166:167], v21 offset:2048
    ds_read_b64_tr_b16 v[168:169], v22 offset:0
    ds_read_b64_tr_b16 v[170:171], v22 offset:2048
    ds_read_b64_tr_b16 v[172:173], v23 offset:0
    ds_read_b64_tr_b16 v[174:175], v23 offset:2048
    ds_read_b64_tr_b16 v[176:177], v20 offset:4096
    ds_read_b64_tr_b16 v[178:179], v20 offset:6144
    ds_read_b64_tr_b16 v[180:181], v21 offset:4096
    ds_read_b64_tr_b16 v[182:183], v21 offset:6144
    ds_read_b64_tr_b16 v[184:185], v22 offset:4096
    ds_read_b64_tr_b16 v[186:187], v22 offset:6144
    ds_read_b64_tr_b16 v[188:189], v23 offset:4096
    ds_read_b64_tr_b16 v[190:191], v23 offset:6144
    s_add_u32 s52, s52, 2135587861
    s_addc_u32 s53, s53, 2654435769
    s_mov_b32 s58, 0
    s_cmp_eq_u32 s47, 7
    s_waitcnt lgkmcnt(0)
    s_cbranch_scc1 L_q10
    s_barrier
L_nob9:
    s_lshl_b32 s54, s4, 3
    s_add_u32 m0, s61, 36864
    s_add_u32 s54, s54, 32768
    buffer_load_dwordx4 v10, s[28:31], s54 offen offset:0  lds
    buffer_load_dwordx4 v11, s[28:31], s54 offen offset:1024  lds
    buffer_load_dwordx4 v12, s[28:31], s54 offen offset:2048  lds
    buffer_load_dwordx4 v13, s[28:31], s54 offen offset:3072  lds
    s_lshl_b32 s54, s5, 3
    s_add_u32 m0, s61, 65536
    s_add_u32 s54, s54, 32768
    buffer_load_dwordx4 v10, s[28:31], s54 offen offset:0  lds
    buffer_load_dwordx4 v11, s[28:31], s54 offen offset:1024  lds
    buffer_load_dwordx4 v12, s[28:31], s54 offen offset:2048  lds
    buffer_load_dwordx4 v13, s[28:31], s54 offen offset:3072  lds
    s_lshl_b32 s54, s6, 3
    s_add_u32 m0, s61, 69632
    s_add_u32 s54, s54, 32768
    buffer_load_dwordx4 v10, s[28:31], s54 offen offset:0  lds
    buffer_load_dwordx4 v11, s[28:31], s54 offen offset:1024  lds
    buffer_load_dwordx4 v12, s[28:31], s54 offen offset:2048  lds
    buffer_load_dwordx4 v13, s[28:31], s54 offen offset:3072  lds
L_q10:
    s_lshl_b32 s54, s7, 3
    s_add_u32 m0, s61, 98304
    s_add_u32 s54, s54, 32768
    buffer_load_dwordx4 v10, s[28:31], s54 offen offset:0  lds
    buffer_load_dwordx4 v11, s[28:31], s54 offen offset:1024  lds
    buffer_load_dwordx4 v12, s[28:31], s54 offen offset:2048  lds
    buffer_load_dwordx4 v13, s[28:31], s54 offen offset:3072  lds
    s_load_dwordx2 s[20:21], s[18:19], 1024 glc
    s_load_dwordx2 s[22:23], s[18:19], 1152 glc
    s_load_dwordx2 s[24:25], s[18:19], 1280 glc
    s_load_dwordx2 s[26:27], s[18:19], 1408 glc
    s_load_dwordx2 s[40:41], s[18:19], 1536 glc
    s_load_dwordx2 s[42:43], s[18:19], 1664 glc
    s_load_dwordx2 s[14:15], s[18:19], 1792 glc
    s_lshl_b32 s54, s8, 3
    s_add_u32 m0, s61, 102400
    s_add_u32 s54, s54, 32768
    buffer_load_dwordx4 v10, s[28:31], s54 offen offset:0  lds
    buffer_load_dwordx4 v11, s[28:31], s54 offen offset:1024  lds
    buffer_load_dwordx4 v12, s[28:31], s54 offen offset:2048  lds
    buffer_load_dwordx4 v13, s[28:31], s54 offen offset:3072  lds
    s_lshl_b32 s54, s9, 3
    s_add_u32 m0, s61, 131072
    s_add_u32 s54, s54, 32768
    buffer_load_dwordx4 v10, s[28:31], s54 offen offset:0  lds
    buffer_load_dwordx4 v11, s[28:31], s54 offen offset:1024  lds
    buffer_load_dwordx4 v12, s[28:31], s54 offen offset:2048  lds
    buffer_load_dwordx4 v13, s[28:31], s54 offen offset:3072  lds
    s_cmp_lg_u32 s47, 7
    s_cbranch_scc1 L_spAchk
    s_lshl_b32 s54, s10, 3
    s_add_u32 m0, s61, 135168
    s_add_u32 s54, s54, 32768
    buffer_load_dwordx4 v10, s[28:31], s54 offen offset:0  lds
    buffer_load_dwordx4 v11, s[28:31], s54 offen offset:1024  lds
    buffer_load_dwordx4 v12, s[28:31], s54 offen offset:2048  lds
    buffer_load_dwordx4 v13, s[28:31], s54 offen offset:3072  lds
    s_waitcnt lgkmcnt(0)
L_ipoll:
    s_load_dwordx2 s[20:21], s[18:19], 1024 glc
    s_add_u32 s58, s58, 1
    s_waitcnt lgkmcnt(0)
    s_cmp_eq_u64 s[20:21], s[52:53]
    s_cbranch_scc1 L_spA
    s_cmp_lt_u32 s58, 0x400000
    s_cbranch_scc1 L_ipoll
L_spA:
    s_load_dwordx2 s[20:21], s[18:19], 1024 glc
    s_load_dwordx2 s[22:23], s[18:19], 1152 glc
    s_load_dwordx2 s[24:25], s[18:19], 1280 glc
    s_load_dwordx2 s[26:27], s[18:19], 1408 glc
    s_load_dwordx2 s[40:41], s[18:19], 1536 glc
    s_load_dwordx2 s[42:43], s[18:19], 1664 glc
    s_load_dwordx2 s[14:15], s[18:19], 1792 glc
L_spAchk:
    s_waitcnt lgkmcnt(0)
    s_xor_b64 s[20:21], s[20:21], s[52:53]
    s_xor_b64 s[22:23], s[22:23], s[52:53]
    s_xor_b64 s[24:25], s[24:25], s[52:53]
    s_xor_b64 s[26:27], s[26:27], s[52:53]
    s_xor_b64 s[40:41], s[40:41], s[52:53]
    s_xor_b64 s[42:43], s[42:43], s[52:53]
    s_xor_b64 s[14:15], s[14:15], s[52:53]
    s_or_b64 s[20:21], s[20:21], s[22:23]
    s_or_b64 s[24:25], s[24:25], s[26:27]
    s_or_b64 s[40:41], s[40:41], s[42:43]
    s_or_b64 s[20:21], s[20:21], s[24:25]
    s_or_b64 s[40:41], s[40:41], s[14:15]
    s_or_b64 s[20:21], s[20:21], s[40:41]
    s_cbranch_scc0 L_spAx
    s_add_u32 s58, s58, 1
    s_cmp_lt_u32 s58, 0x400000
    s_cbranch_scc1 L_spA
    s_branch L_spAx
    .p2align 12
L_stub1:
    s_branch L_touched
L_spAx:
    buffer_load_dwordx4 v[192:195], v9, s[32:35], s4 offen offset:0 sc1
    buffer_load_dwordx4 v[196:199], v9, s[32:35], s5 offen offset:0 sc1
    buffer_load_dwordx4 v[200:203], v9, s[32:35], s4 offen offset:1024 sc1
    buffer_load_dwordx4 v[204:207], v9, s[32:35], s5 offen offset:1024 sc1
    s_lshl_b32 s54, s10, 3
    s_add_u32 m0, s61, 135168
    s_add_u32 s54, s54, 32768
    buffer_load_dwordx4 v10, s[28:31], s54 offen offset:0  lds
    buffer_load_dwordx4 v11, s[28:31], s54 offen offset:1024  lds
    buffer_load_dwordx4 v12, s[28:31], s54 offen offset:2048  lds
    buffer_load_dwordx4 v13, s[28:31], s54 offen offset:3072  lds
    buffer_load_dwordx4 v[208:211], v9, s[32:35], s4 offen offset:2048 sc1
    buffer_load_dwordx4 v[212:215], v9, s[32:35], s5 offen offset:2048 sc1
    buffer_load_dwordx4 v[216:219], v9, s[32:35], s4 offen offset:3072 sc1
    buffer_load_dwordx4 v[220:223], v9, s[32:35], s5 offen offset:3072 sc1
    s_waitcnt vmcnt(10)
    v_mfma_f32_16x16x32_bf16 v[96:99], v[32:35], v[192:195], 0
    v_mfma_f32_16x16x32_bf16 v[96:99], v[48:51], v[196:199], v[96:99]
    v_mfma_f32_16x16x32_bf16 v[100:103], v[52:55], v[196:199], 0
    buffer_load_dwordx4 v[224:227], v9, s[32:35], s6 offen offset:0 sc1
    v_mfma_f32_16x16x32_bf16 v[100:103], v[36:39], v[192:195], v[100:103]
    v_mfma_f32_16x16x32_bf16 v[104:107], v[40:43], v[192:195], 0
    v_mfma_f32_16x16x32_bf16 v[104:107], v[56:59], v[196:199], v[104:107]
    buffer_load_dwordx4 v[228:231], v9, s[32:35], s7 offen offset:0 sc1
    v_mfma_f32_16x16x32_bf16 v[108:111], v[60:63], v[196:199], 0
    v_mfma_f32_16x16x32_bf16 v[108:111], v[44:47], v[192:195], v[108:111]
    s_waitcnt vmcnt(10)
    v_mfma_f32_16x16x32_bf16 v[112:115], v[32:35], v[200:203], 0
    ds_read_b64_tr_b16 v[240:241], v20 offset:32768
    v_mfma_f32_16x16x32_bf16 v[112:115], v[48:51], v[204:207], v[112:115]
    ds_read_b64_tr_b16 v[242:243], v20 offset:34816
    v_mfma_f32_16x16x32_bf16 v[116:119], v[52:55], v[204:207], 0
    buffer_load_dwordx4 v[232:235], v9, s[32:35], s6 offen offset:1024 sc1
    v_mfma_f32_16x16x32_bf16 v[116:119], v[36:39], v[200:203], v[116:119]
    v_mfma_f32_16x16x32_bf16 v[120:123], v[40:43], v[200:203], 0
    ds_read_b64_tr_b16 v[244:245], v21 offset:32768
    v_mfma_f32_16x16x32_bf16 v[120:123], v[56:59], v[204:207], v[120:123]
    buffer_load_dwordx4 v[236:239], v9, s[32:35], s7 offen offset:1024 sc1
    v_mfma_f32_16x16x32_bf16 v[124:127], v[60:63], v[204:207], 0
    ds_read_b64_tr_b16 v[246:247], v21 offset:34816
    v_mfma_f32_16x16x32_bf16 v[124:127], v[44:47], v[200:203], v[124:127]
    s_waitcnt vmcnt(6)
    v_mfma_f32_16x16x32_bf16 v[128:131], v[32:35], v[208:211], 0
    ds_read_b64_tr_b16 v[248:249], v22 offset:32768
    v_mfma_f32_16x16x32_bf16 v[128:131], v[48:51], v[212:215], v[128:131]
    ds_read_b64_tr_b16 v[250:251], v22 offset:34816
    v_mfma_f32_16x16x32_bf16 v[132:135], v[52:55], v[212:215], 0
    buffer_load_dwordx4 v[192:195], v9, s[32:35], s6 offen offset:2048 sc1
    v_mfma_f32_16x16x32_bf16 v[132:135], v[36:39], v[208:211], v[132:135]
    v_mfma_f32_16x16x32_bf16 v[136:139], v[40:43], v[208:211], 0
    ds_read_b64_tr_b16 v[252:253], v23 offset:32768
    v_mfma_f32_16x16x32_bf16 v[136:139], v[56:59], v[212:215], v[136:139]
    buffer_load_dwordx4 v[196:199], v9, s[32:35], s7 offen offset:2048 sc1
    v_mfma_f32_16x16x32_bf16 v[140:143], v[60:63], v[212:215], 0
    ds_read_b64_tr_b16 v[254:255], v23 offset:34816
    v_mfma_f32_16x16x32_bf16 v[140:143], v[44:47], v[208:211], v[140:143]
    s_waitcnt vmcnt(6)
    v_mfma_f32_16x16x32_bf16 v[144:147], v[32:35], v[216:219], 0
    v_mfma_f32_16x16x32_bf16 v[144:147], v[48:51], v[220:223], v[144:147]
    v_mfma_f32_16x16x32_bf16 v[148:151], v[52:55], v[220:223], 0
    buffer_load_dwordx4 v[200:203], v9, s[32:35], s6 offen offset:3072 sc1
    v_mfma_f32_16x16x32_bf16 v[148:151], v[36:39], v[216:219], v[148:151]
    v_mfma_f32_16x16x32_bf16 v[152:155], v[40:43], v[216:219], 0
    v_mfma_f32_16x16x32_bf16 v[152:155], v[56:59], v[220:223], v[152:155]
    buffer_load_dwordx4 v[204:207], v9, s[32:35], s7 offen offset:3072 sc1
    v_mfma_f32_16x16x32_bf16 v[156:159], v[60:63], v[220:223], 0
    v_mfma_f32_16x16x32_bf16 v[156:159], v[44:47], v[216:219], v[156:159]
    s_waitcnt vmcnt(6)
    v_mfma_f32_16x16x32_bf16 v[96:99], v[64:67], v[224:227], v[96:99]
    ds_read_b64_tr_b16 v[32:33], v20 offset:36864
    v_mfma_f32_16x16x32_bf16 v[96:99], v[80:83], v[228:231], v[96:99]
    ds_read_b64_tr_b16 v[34:35], v20 offset:38912
    v_mfma_f32_16x16x32_bf16 v[100:103], v[84:87], v[228:231], v[100:103]
    buffer_load_dwordx4 v[208:211], v9, s[32:35], s8 offen offset:0 sc1
    v_mfma_f32_16x16x32_bf16 v[100:103], v[68:71], v[224:227], v[100:103]
    v_mfma_f32_16x16x32_bf16 v[104:107], v[72:75], v[224:227], v[104:107]
    ds_read_b64_tr_b16 v[36:37], v21 offset:36864
    v_mfma_f32_16x16x32_bf16 v[104:107], v[88:91], v[228:231], v[104:107]
    buffer_load_dwordx4 v[212:215], v9, s[32:35], s9 offen offset:0 sc1
    v_mfma_f32_16x16x32_bf16 v[108:111], v[92:95], v[228:231], v[108:111]
    ds_read_b64_tr_b16 v[38:39], v21 offset:38912
    v_mfma_f32_16x16x32_bf16 v[108:111], v[76:79], v[224:227], v[108:111]
    s_waitcnt vmcnt(6)
    v_mfma_f32_16x16x32_bf16 v[112:115], v[64:67], v[232:235], v[112:115]
    ds_read_b64_tr_b16 v[40:41], v22 offset:36864
    v_mfma_f32_16x16x32_bf16 v[112:115], v[80:83], v[236:239], v[112:115]
    ds_read_b64_tr_b16 v[42:43], v22 offset:38912
    v_mfma_f32_16x16x32_bf16 v[116:119], v[84:87], v[236:239], v[116:119]
    buffer_load_dwordx4 v[216:219], v9, s[32:35], s8 offen offset:1024 sc1
    v_mfma_f32_16x16x32_bf16 v[116:119], v[68:71], v[232:235], v[116:119]
    v_mfma_f32_16x16x32_bf16 v[120:123], v[72:75], v[232:235], v[120:123]
    ds_read_b64_tr_b16 v[44:45], v23 offset:36864
    v_mfma_f32_16x16x32_bf16 v[120:123], v[88:91], v[236:239], v[120:123]
    buffer_load_dwordx4 v[220:223], v9, s[32:35], s9 offen offset:1024 sc1
    v_mfma_f32_16x16x32_bf16 v[124:127], v[92:95], v[236:239], v[124:127]
    ds_read_b64_tr_b16 v[46:47], v23 offset:38912
    v_mfma_f32_16x16x32_bf16 v[124:127], v[76:79], v[232:235], v[124:127]
    s_waitcnt vmcnt(6)
    v_mfma_f32_16x16x32_bf16 v[128:131], v[64:67], v[192:195], v[128:131]
    ds_read_b64_tr_b16 v[48:49], v24 offset:0
    v_mfma_f32_16x16x32_bf16 v[128:131], v[80:83], v[196:199], v[128:131]
    ds_read_b64_tr_b16 v[50:51], v24 offset:2048
    v_mfma_f32_16x16x32_bf16 v[132:135], v[84:87], v[196:199], v[132:135]
    buffer_load_dwordx4 v[224:227], v9, s[32:35], s8 offen offset:2048 sc1
    global_load_dwordx2 v[14:15], v16, s[62:63] offset:1024 sc1
    v_mfma_f32_16x16x32_bf16 v[132:135], v[68:71], v[192:195], v[132:135]
    v_mfma_f32_16x16x32_bf16 v[136:139], v[72:75], v[192:195], v[136:139]
    ds_read_b64_tr_b16 v[52:53], v25 offset:0
    v_mfma_f32_16x16x32_bf16 v[136:139], v[88:91], v[196:199], v[136:139]
    buffer_load_dwordx4 v[228:231], v9, s[32:35], s9 offen offset:2048 sc1
    v_mfma_f32_16x16x32_bf16 v[140:143], v[92:95], v[196:199], v[140:143]
    ds_read_b64_tr_b16 v[54:55], v25 offset:2048
    v_mfma_f32_16x16x32_bf16 v[140:143], v[76:79], v[192:195], v[140:143]
    s_waitcnt vmcnt(7)
    v_mfma_f32_16x16x32_bf16 v[144:147], v[64:67], v[200:203], v[144:147]
    ds_read_b64_tr_b16 v[56:57], v26 offset:0
    v_mfma_f32_16x16x32_bf16 v[144:147], v[80:83], v[204:207], v[144:147]
    ds_read_b64_tr_b16 v[58:59], v26 offset:2048
    v_mfma_f32_16x16x32_bf16 v[148:151], v[84:87], v[204:207], v[148:151]
    buffer_load_dwordx4 v[232:235], v9, s[32:35], s8 offen offset:3072 sc1
    v_mfma_f32_16x16x32_bf16 v[148:151], v[68:71], v[200:203], v[148:151]
    v_mfma_f32_16x16x32_bf16 v[152:155], v[72:75], v[200:203], v[152:155]
    ds_read_b64_tr_b16 v[60:61], v27 offset:0
    v_mfma_f32_16x16x32_bf16 v[152:155], v[88:91], v[204:207], v[152:155]
    buffer_load_dwordx4 v[236:239], v9, s[32:35], s9 offen offset:3072 sc1
    v_mfma_f32_16x16x32_bf16 v[156:159], v[92:95], v[204:207], v[156:159]
    ds_read_b64_tr_b16 v[62:63], v27 offset:2048
    v_mfma_f32_16x16x32_bf16 v[156:159], v[76:79], v[200:203], v[156:159]
    s_waitcnt vmcnt(7)
    v_mfma_f32_16x16x32_bf16 v[96:99], v[160:163], v[208:211], v[96:99]
    ds_read_b64_tr_b16 v[64:65], v24 offset:4096
    v_mfma_f32_16x16x32_bf16 v[96:99], v[176:179], v[212:215], v[96:99]
    ds_read_b64_tr_b16 v[66:67], v24 offset:6144
    v_mfma_f32_16x16x32_bf16 v[100:103], v[180:183], v[212:215], v[100:103]
    buffer_load_dwordx4 v[192:195], v9, s[32:35], s10 offen offset:0 sc1
    v_mfma_f32_16x16x32_bf16 v[100:103], v[164:167], v[208:211], v[100:103]
    v_mfma_f32_16x16x32_bf16 v[104:107], v[168:171], v[208:211], v[104:107]
    ds_read_b64_tr_b16 v[68:69], v25 offset:4096
    v_mfma_f32_16x16x32_bf16 v[104:107], v[184:187], v[212:215], v[104:107]
    buffer_load_dwordx4 v[196:199], v9, s[32:35], s10 offen offset:1024 sc1
    v_mfma_f32_16x16x32_bf16 v[108:111], v[188:191], v[212:215], v[108:111]
    ds_read_b64_tr_b16 v[70:71], v25 offset:6144
    v_mfma_f32_16x16x32_bf16 v[108:111], v[172:175], v[208:211], v[108:111]
    s_waitcnt vmcnt(7)
    v_mfma_f32_16x16x32_bf16 v[112:115], v[160:163], v[216:219], v[112:115]
    ds_read_b64_tr_b16 v[72:73], v26 offset:4096
    v_mfma_f32_16x16x32_bf16 v[112:115], v[176:179], v[220:223], v[112:115]
    ds_read_b64_tr_b16 v[74:75], v26 offset:6144
    v_mfma_f32_16x16x32_bf16 v[116:119], v[180:183], v[220:223], v[116:119]
    buffer_load_dwordx4 v[200:203], v9, s[32:35], s10 offen offset:2048 sc1
    v_mfma_f32_16x16x32_bf16 v[116:119], v[164:167], v[216:219], v[116:119]
    v_mfma_f32_16x16x32_bf16 v[120:123], v[168:171], v[216:219], v[120:123]
    ds_read_b64_tr_b16 v[76:77], v27 offset:4096
    v_mfma_f32_16x16x32_bf16 v[120:123], v[184:187], v[220:223], v[120:123]
    buffer_load_dwordx4 v[204:207], v9, s[32:35], s10 offen offset:3072 sc1
    v_mfma_f32_16x16x32_bf16 v[124:127], v[188:191], v[220:223], v[124:127]
    ds_read_b64_tr_b16 v[78:79], v27 offset:6144
    v_mfma_f32_16x16x32_bf16 v[124:127], v[172:175], v[216:219], v[124:127]
    s_waitcnt vmcnt(6)
    v_mfma_f32_16x16x32_bf16 v[128:131], v[160:163], v[224:227], v[128:131]
    ds_read_b64_tr_b16 v[80:81], v24 offset:32768
    v_mfma_f32_16x16x32_bf16 v[128:131], v[176:179], v[228:231], v[128:131]
    ds_read_b64_tr_b16 v[82:83], v24 offset:34816
    v_mfma_f32_16x16x32_bf16 v[132:135], v[180:183], v[228:231], v[132:135]
    s_waitcnt vmcnt(7)
    v_cmp_ne_u64 vcc, s[52:53], v[14:15]
    s_cbranch_vccnz L_spB14
L_spB14x:
    buffer_load_dwordx4 v[208:211], v1, s[32:35], s4 offen offset:0 sc1
    v_mfma_f32_16x16x32_bf16 v[132:135], v[164:167], v[224:227], v[132:135]
    v_mfma_f32_16x16x32_bf16 v[136:139], v[168:171], v[224:227], v[136:139]
    ds_read_b64_tr_b16 v[84:85], v25 offset:32768
    v_mfma_f32_16x16x32_bf16 v[136:139], v[184:187], v[228:231], v[136:139]
    buffer_load_dwordx4 v[212:215], v1, s[32:35], s5 offen offset:0 sc1
    v_mfma_f32_16x16x32_bf16 v[140:143], v[188:191], v[228:231], v[140:143]
    ds_read_b64_tr_b16 v[86:87], v25 offset:34816
    v_mfma_f32_16x16x32_bf16 v[140:143], v[172:175], v[224:227], v[140:143]
    s_waitcnt vmcnt(6)
    v_mfma_f32_16x16x32_bf16 v[144:147], v[160:163], v[232:235], v[144:147]
    ds_read_b64_tr_b16 v[88:89], v26 offset:32768
    v_mfma_f32_16x16x32_bf16 v[144:147], v[176:179], v[236:239], v[144:147]
    ds_read_b64_tr_b16 v[90:91], v26 offset:34816
    v_mfma_f32_16x16x32_bf16 v[148:151], v[180:183], v[236:239], v[148:151]
    buffer_load_dwordx4 v[216:219], v1, s[32:35], s4 offen offset:1024 sc1
    v_mfma_f32_16x16x32_bf16 v[148:151], v[164:167], v[232:235], v[148:151]
    v_mfma_f32_16x16x32_bf16 v[152:155], v[168:171], v[232:235], v[152:155]
    ds_read_b64_tr_b16 v[92:93], v27 offset:32768
    v_mfma_f32_16x16x32_bf16 v[152:155], v[184:187], v[236:239], v[152:155]
    buffer_load_dwordx4 v[220:223], v1, s[32:35], s5 offen offset:1024 sc1
    v_mfma_f32_16x16x32_bf16 v[156:159], v[188:191], v[236:239], v[156:159]
    ds_read_b64_tr_b16 v[94:95], v27 offset:34816
    v_mfma_f32_16x16x32_bf16 v[156:159], v[172:175], v[232:235], v[156:159]
    s_waitcnt vmcnt(6) lgkmcnt(15)
    v_mfma_f32_16x16x32_bf16 v[96:99], v[240:243], v[192:195], v[96:99]
    ds_read_b64_tr_b16 v[160:161], v24 offset:36864
    v_mfma_f32_16x16x32_bf16 v[100:103], v[244:247], v[192:195], v[100:103]
    ds_read_b64_tr_b16 v[162:163], v24 offset:38912
    v_mfma_f32_16x16x32_bf16 v[104:107], v[248:251], v[192:195], v[104:107]
    buffer_load_dwordx4 v[224:227], v1, s[32:35], s6 offen offset:0 sc1
    v_mfma_f32_16x16x32_bf16 v[108:111], v[252:255], v[192:195], v[108:111]
    v_mfma_f32_16x16x32_bf16 v[124:127], v[252:255], v[196:199], v[124:127]
    ds_read_b64_tr_b16 v[164:165], v25 offset:36864
    v_mfma_f32_16x16x32_bf16 v[120:123], v[248:251], v[196:199], v[120:123]
    buffer_load_dwordx4 v[228:231], v1, s[32:35], s7 offen offset:0 sc1
    v_mfma_f32_16x16x32_bf16 v[116:119], v[244:247], v[196:199], v[116:119]
    ds_read_b64_tr_b16 v[166:167], v25 offset:38912
    v_mfma_f32_16x16x32_bf16 v[112:115], v[240:243], v[196:199], v[112:115]
    s_waitcnt vmcnt(6)
    v_mfma_f32_16x16x32_bf16 v[128:131], v[240:243], v[200:203], v[128:131]
    ds_read_b64_tr_b16 v[168:169], v26 offset:36864
    v_mfma_f32_16x16x32_bf16 v[132:135], v[244:247], v[200:203], v[132:135]
    ds_read_b64_tr_b16 v[170:171], v26 offset:38912
    v_mfma_f32_16x16x32_bf16 v[136:139], v[248:251], v[200:203], v[136:139]
    buffer_load_dwordx4 v[232:235], v1, s[32:35], s6 offen offset:1024 sc1
    v_mfma_f32_16x16x32_bf16 v[140:143], v[252:255], v[200:203], v[140:143]
    v_mfma_f32_16x16x32_bf16 v[156:159], v[252:255], v[204:207], v[156:159]
    ds_read_b64_tr_b16 v[172:173], v27 offset:36864
    v_mfma_f32_16x16x32_bf16 v[152:155], v[248:251], v[204:207], v[152:155]
    buffer_load_dwordx4 v[236:239], v1, s[32:35], s7 offen offset:1024 sc1
    v_mfma_f32_16x16x32_bf16 v[148:151], v[244:247], v[204:207], v[148:151]
    ds_read_b64_tr_b16 v[174:175], v27 offset:38912
    v_mfma_f32_16x16x32_bf16 v[144:147], v[240:243], v[204:207], v[144:147]
    s_waitcnt vmcnt(6) lgkmcnt(15)
    v_mfma_f32_16x16x32_bf16 v[96:99], v[32:35], v[208:211], v[96:99]
    ds_read_b64_tr_b16 v[176:177], v28 offset:0
    v_mfma_f32_16x16x32_bf16 v[96:99], v[48:51], v[212:215], v[96:99]
    ds_read_b64_tr_b16 v[178:179], v28 offset:2048
    v_mfma_f32_16x16x32_bf16 v[100:103], v[52:55], v[212:215], v[100:103]
    buffer_load_dwordx4 v[192:195], v1, s[32:35], s8 offen offset:0 sc1
    v_mfma_f32_16x16x32_bf16 v[100:103], v[36:39], v[208:211], v[100:103]
    v_mfma_f32_16x16x32_bf16 v[104:107], v[40:43], v[208:211], v[104:107]
    ds_read_b64_tr_b16 v[180:181], v29 offset:0
    v_mfma_f32_16x16x32_bf16 v[104:107], v[56:59], v[212:215], v[104:107]
    buffer_load_dwordx4 v[196:199], v1, s[32:35], s9 offen offset:0 sc1
    v_mfma_f32_16x16x32_bf16 v[108:111], v[60:63], v[212:215], v[108:111]
    ds_read_b64_tr_b16 v[182:183], v29 offset:2048
    v_mfma_f32_16x16x32_bf16 v[108:111], v[44:47], v[208:211], v[108:111]
    s_waitcnt vmcnt(6)
    v_mfma_f32_16x16x32_bf16 v[112:115], v[32:35], v[216:219], v[112:115]
    ds_read_b64_tr_b16 v[184:185], v30 offset:0
    v_mfma_f32_16x16x32_bf16 v[112:115], v[48:51], v[220:223], v[112:115]
    ds_read_b64_tr_b16 v[186:187], v30 offset:2048
    v_mfma_f32_16x16x32_bf16 v[116:119], v[52:55], v[220:223], v[116:119]
    buffer_load_dwordx4 v[200:203], v1, s[32:35], s8 offen offset:1024 sc1
    v_mfma_f32_16x16x32_bf16 v[116:119], v[36:39], v[216:219], v[116:119]
    v_mfma_f32_16x16x32_bf16 v[120:123], v[40:43], v[216:219], v[120:123]
    ds_read_b64_tr_b16 v[188:189], v31 offset:0
    v_mfma_f32_16x16x32_bf16 v[120:123], v[56:59], v[220:223], v[120:123]
    buffer_load_dwordx4 v[204:207], v1, s[32:35], s9 offen offset:1024 sc1
    v_mfma_f32_16x16x32_bf16 v[124:127], v[60:63], v[220:223], v[124:127]
    ds_read_b64_tr_b16 v[190:191], v31 offset:2048
    v_mfma_f32_16x16x32_bf16 v[124:127], v[44:47], v[216:219], v[124:127]
    s_waitcnt vmcnt(6) lgkmcnt(15)
    v_mfma_f32_16x16x32_bf16 v[96:99], v[64:67], v[224:227], v[96:99]
    ds_read_b64_tr_b16 v[240:241], v28 offset:4096
    v_mfma_f32_16x16x32_bf16 v[96:99], v[80:83], v[228:231], v[96:99]
    ds_read_b64_tr_b16 v[242:243], v28 offset:6144
    v_mfma_f32_16x16x32_bf16 v[100:103], v[84:87], v[228:231], v[100:103]
    buffer_load_dwordx4 v[208:211], v1, s[32:35], s10 offen offset:0 sc1
    v_mfma_f32_16x16x32_bf16 v[100:103], v[68:71], v[224:227], v[100:103]
    v_mfma_f32_16x16x32_bf16 v[104:107], v[72:75], v[224:227], v[104:107]
    ds_read_b64_tr_b16 v[244:245], v29 offset:4096
    v_mfma_f32_16x16x32_bf16 v[104:107], v[88:91], v[228:231], v[104:107]
    buffer_load_dwordx4 v[212:215], v1, s[32:35], s10 offen offset:1024 sc1
    v_mfma_f32_16x16x32_bf16 v[108:111], v[92:95], v[228:231], v[108:111]
    ds_read_b64_tr_b16 v[246:247], v29 offset:6144
    v_mfma_f32_16x16x32_bf16 v[108:111], v[76:79], v[224:227], v[108:111]
    s_waitcnt vmcnt(6)
    v_mfma_f32_16x16x32_bf16 v[112:115], v[64:67], v[232:235], v[112:115]
    ds_read_b64_tr_b16 v[248:249], v30 offset:4096
    v_mfma_f32_16x16x32_bf16 v[112:115], v[80:83], v[236:239], v[112:115]
    ds_read_b64_tr_b16 v[250:251], v30 offset:6144
    v_mfma_f32_16x16x32_bf16 v[116:119], v[84:87], v[236:239], v[116:119]
    buffer_load_dwordx4 v[216:219], v1, s[32:35], s4 offen offset:2048 sc1
    v_mfma_f32_16x16x32_bf16 v[116:119], v[68:71], v[232:235], v[116:119]
    v_mfma_f32_16x16x32_bf16 v[120:123], v[72:75], v[232:235], v[120:123]
    ds_read_b64_tr_b16 v[252:253], v31 offset:4096
    v_mfma_f32_16x16x32_bf16 v[120:123], v[88:91], v[236:239], v[120:123]
    buffer_load_dwordx4 v[220:223], v1, s[32:35], s5 offen offset:2048 sc1
    v_mfma_f32_16x16x32_bf16 v[124:127], v[92:95], v[236:239], v[124:127]
    ds_read_b64_tr_b16 v[254:255], v31 offset:6144
    v_mfma_f32_16x16x32_bf16 v[124:127], v[76:79], v[232:235], v[124:127]
    s_waitcnt vmcnt(6) lgkmcnt(8)
    v_mfma_f32_16x16x32_bf16 v[96:99], v[160:163], v[192:195], v[96:99]
    v_mfma_f32_16x16x32_bf16 v[96:99], v[176:179], v[196:199], v[96:99]
    v_mfma_f32_16x16x32_bf16 v[100:103], v[180:183], v[196:199], v[100:103]
    buffer_load_dwordx4 v[224:227], v1, s[32:35], s6 offen offset:2048 sc1
    v_mfma_f32_16x16x32_bf16 v[100:103], v[164:167], v[192:195], v[100:103]
    v_mfma_f32_16x16x32_bf16 v[104:107], v[168:171], v[192:195], v[104:107]
    v_mfma_f32_16x16x32_bf16 v[104:107], v[184:187], v[196:199], v[104:107]
    buffer_load_dwordx4 v[228:231], v1, s[32:35], s7 offen offset:2048 sc1
    v_mfma_f32_16x16x32_bf16 v[108:111], v[188:191], v[196:199], v[108:111]
    v_mfma_f32_16x16x32_bf16 v[108:111], v[172:175], v[192:195], v[108:111]
    s_waitcnt vmcnt(6)
    v_mfma_f32_16x16x32_bf16 v[112:115], v[160:163], v[200:203], v[112:115]
    v_mfma_f32_16x16x32_bf16 v[112:115], v[176:179], v[204:207], v[112:115]
    v_mfma_f32_16x16x32_bf16 v[116:119], v[180:183], v[204:207], v[116:119]
    buffer_load_dwordx4 v[232:235], v1, s[32:35], s8 offen offset:2048 sc1
    v_mfma_f32_16x16x32_bf16 v[116:119], v[164:167], v[200:203], v[116:119]
    v_mfma_f32_16x16x32_bf16 v[120:123], v[168:171], v[200:203], v[120:123]
    v_mfma_f32_16x16x32_bf16 v[120:123], v[184:187], v[204:207], v[120:123]
    buffer_load_dwordx4 v[236:239], v1, s[32:35], s9 offen offset:2048 sc1
    v_mfma_f32_16x16x32_bf16 v[124:127], v[188:191], v[204:207], v[124:127]
    v_mfma_f32_16x16x32_bf16 v[124:127], v[172:175], v[200:203], v[124:127]
    s_waitcnt vmcnt(6) lgkmcnt(0)
    v_mfma_f32_16x16x32_bf16 v[96:99], v[240:243], v[208:211], v[96:99]
    v_mfma_f32_16x16x32_bf16 v[100:103], v[244:247], v[208:211], v[100:103]
    v_mfma_f32_16x16x32_bf16 v[104:107], v[248:251], v[208:211], v[104:107]
    buffer_load_dwordx4 v[192:195], v1, s[32:35], s10 offen offset:2048 sc1
    v_mfma_f32_16x16x32_bf16 v[108:111], v[252:255], v[208:211], v[108:111]
    v_mfma_f32_16x16x32_bf16 v[124:127], v[252:255], v[212:215], v[124:127]
    v_mfma_f32_16x16x32_bf16 v[120:123], v[248:251], v[212:215], v[120:123]
    buffer_load_dwordx4 v[196:199], v1, s[32:35], s10 offen offset:3072 sc1
    v_mfma_f32_16x16x32_bf16 v[116:119], v[244:247], v[212:215], v[116:119]
    v_mfma_f32_16x16x32_bf16 v[112:115], v[240:243], v[212:215], v[112:115]
    s_waitcnt vmcnt(6)
    v_mfma_f32_16x16x32_bf16 v[128:131], v[32:35], v[216:219], v[128:131]
    v_mfma_f32_16x16x32_bf16 v[128:131], v[48:51], v[220:223], v[128:131]
    v_mfma_f32_16x16x32_bf16 v[132:135], v[52:55], v[220:223], v[132:135]
    buffer_load_dwordx4 v[200:203], v1, s[32:35], s4 offen offset:3072 sc1
    v_mfma_f32_16x16x32_bf16 v[132:135], v[36:39], v[216:219], v[132:135]
    v_mfma_f32_16x16x32_bf16 v[136:139], v[40:43], v[216:219], v[136:139]
    v_mfma_f32_16x16x32_bf16 v[136:139], v[56:59], v[220:223], v[136:139]
    buffer_load_dwordx4 v[204:207], v1, s[32:35], s5 offen offset:3072 sc1
    ds_write_b128 v4, v[96:99] offset:0
    v_mfma_f32_16x16x32_bf16 v[140:143], v[60:63], v[220:223], v[140:143]
    v_mfma_f32_16x16x32_bf16 v[140:143], v[44:47], v[216:219], v[140:143]
    ds_write_b128 v5, v[100:103] offset:1024
    s_waitcnt vmcnt(6)
    v_mfma_f32_16x16x32_bf16 v[128:131], v[64:67], v[224:227], v[128:131]
    v_mfma_f32_16x16x32_bf16 v[128:131], v[80:83], v[228:231], v[128:131]
    v_mfma_f32_16x16x32_bf16 v[132:135], v[84:87], v[228:231], v[132:135]
    buffer_load_dwordx4 v[208:211], v1, s[32:35], s6 offen offset:3072 sc1
    v_mfma_f32_16x16x32_bf16 v[132:135], v[68:71], v[224:227], v[132:135]
    ds_write_b128 v4, v[104:107] offset:2048
    v_mfma_f32_16x16x32_bf16 v[136:139], v[72:75], v[224:227], v[136:139]
    v_mfma_f32_16x16x32_bf16 v[136:139], v[88:91], v[228:231], v[136:139]
    buffer_load_dwordx4 v[212:215], v1, s[32:35], s7 offen offset:3072 sc1
    ds_write_b128 v5, v[108:111] offset:3072
    v_mfma_f32_16x16x32_bf16 v[140:143], v[92:95], v[228:231], v[140:143]
    v_mfma_f32_16x16x32_bf16 v[140:143], v[76:79], v[224:227], v[140:143]
    ds_write_b128 v4, v[112:115] offset:4096
    s_waitcnt vmcnt(6)
    v_mfma_f32_16x16x32_bf16 v[128:131], v[160:163], v[232:235], v[128:131]
    v_mfma_f32_16x16x32_bf16 v[128:131], v[176:179], v[236:239], v[128:131]
    v_mfma_f32_16x16x32_bf16 v[132:135], v[180:183], v[236:239], v[132:135]
    buffer_load_dwordx4 v[216:219], v1, s[32:35], s8 offen offset:3072 sc1
    v_mfma_f32_16x16x32_bf16 v[132:135], v[164:167], v[232:235], v[132:135]
    ds_write_b128 v5, v[116:119] offset:5120
    v_mfma_f32_16x16x32_bf16 v[136:139], v[168:171], v[232:235], v[136:139]
    v_mfma_f32_16x16x32_bf16 v[136:139], v[184:187], v[236:239], v[136:139]
    buffer_load_dwordx4 v[220:223], v1, s[32:35], s9 offen offset:3072 sc1
    ds_write_b128 v4, v[120:123] offset:6144
    v_mfma_f32_16x16x32_bf16 v[140:143], v[188:191], v[236:239], v[140:143]
    v_mfma_f32_16x16x32_bf16 v[140:143], v[172:175], v[232:235], v[140:143]
    ds_write_b128 v5, v[124:127] offset:7168
    s_waitcnt vmcnt(6)
    v_mfma_f32_16x16x32_bf16 v[128:131], v[240:243], v[192:195], v[128:131]
    v_mfma_f32_16x16x32_bf16 v[132:135], v[244:247], v[192:195], v[132:135]
    v_mfma_f32_16x16x32_bf16 v[136:139], v[248:251], v[192:195], v[136:139]
    v_mfma_f32_16x16x32_bf16 v[140:143], v[252:255], v[192:195], v[140:143]
    v_mfma_f32_16x16x32_bf16 v[156:159], v[252:255], v[196:199], v[156:159]
    v_mfma_f32_16x16x32_bf16 v[152:155], v[248:251], v[196:199], v[152:155]
    v_mfma_f32_16x16x32_bf16 v[148:151], v[244:247], v[196:199], v[148:151]
    v_mfma_f32_16x16x32_bf16 v[144:147], v[240:243], v[196:199], v[144:147]
    s_waitcnt vmcnt(4) lgkmcnt(0)
    v_mfma_f32_16x16x32_bf16 v[144:147], v[32:35], v[200:203], v[144:147]
    s_barrier
    v_mfma_f32_16x16x32_bf16 v[144:147], v[48:51], v[204:207], v[144:147]
    v_mfma_f32_16x16x32_bf16 v[148:151], v[52:55], v[204:207], v[148:151]
    v_mfma_f32_16x16x32_bf16 v[148:151], v[36:39], v[200:203], v[148:151]
    v_mfma_f32_16x16x32_bf16 v[152:155], v[40:43], v[200:203], v[152:155]
    v_mfma_f32_16x16x32_bf16 v[152:155], v[56:59], v[204:207], v[152:155]
    ds_write_b128 v4, v[128:131] offset:32768
    v_mfma_f32_16x16x32_bf16 v[156:159], v[60:63], v[204:207], v[156:159]
    v_mfma_f32_16x16x32_bf16 v[156:159], v[44:47], v[200:203], v[156:159]
    ds_write_b128 v5, v[132:135] offset:33792
    s_waitcnt vmcnt(2)
    v_mfma_f32_16x16x32_bf16 v[144:147], v[64:67], v[208:211], v[144:147]
    v_mfma_f32_16x16x32_bf16 v[144:147], v[80:83], v[212:215], v[144:147]
    v_mfma_f32_16x16x32_bf16 v[148:151], v[84:87], v[212:215], v[148:151]
    v_mfma_f32_16x16x32_bf16 v[148:151], v[68:71], v[208:211], v[148:151]
    v_mfma_f32_16x16x32_bf16 v[152:155], v[72:75], v[208:211], v[152:155]
    v_mfma_f32_16x16x32_bf16 v[152:155], v[88:91], v[212:215], v[152:155]
    ds_write_b128 v4, v[136:139] offset:34816
    v_mfma_f32_16x16x32_bf16 v[156:159], v[92:95], v[212:215], v[156:159]
    v_mfma_f32_16x16x32_bf16 v[156:159], v[76:79], v[208:211], v[156:159]
    ds_write_b128 v5, v[140:143] offset:35840
    s_waitcnt vmcnt(0)
    v_mfma_f32_16x16x32_bf16 v[144:147], v[160:163], v[216:219], v[144:147]
    v_mfma_f32_16x16x32_bf16 v[144:147], v[176:179], v[220:223], v[144:147]
    v_mfma_f32_16x16x32_bf16 v[148:151], v[180:183], v[220:223], v[148:151]
    v_mfma_f32_16x16x32_bf16 v[148:151], v[164:167], v[216:219], v[148:151]
    v_mfma_f32_16x16x32_bf16 v[152:155], v[168:171], v[216:219], v[152:155]
    v_mfma_f32_16x16x32_bf16 v[152:155], v[184:187], v[220:223], v[152:155]
    v_mfma_f32_16x16x32_bf16 v[156:159], v[188:191], v[220:223], v[156:159]
    v_mfma_f32_16x16x32_bf16 v[156:159], v[172:175], v[216:219], v[156:159]
    s_nop 1
    ds_write_b128 v4, v[144:147] offset:36864
    s_nop 0
    ds_write_b128 v5, v[148:151] offset:37888
    s_nop 0
    ds_write_b128 v4, v[152:155] offset:38912
    s_nop 0
    ds_write_b128 v5, v[156:159] offset:39936
    s_waitcnt lgkmcnt(0)
    s_barrier
    s_endpgm
L_final:
    s_mov_b64 s[36:37], s[12:13]
    s_mov_b32 s38, 2097152
    s_mov_b32 s39, 0x20000
    v_lshrrev_b32 v3, 3, v2
    v_and_b32 v8, 7, v2
    s_and_b32 s54, s49, 1
    v_lshl_add_u32 v10, s54, 3, v3
    v_and_b32 v11, 3, v8
    v_lshlrev_b32 v11, 2, v11
    v_xor_b32 v10, v10, v11
    v_lshlrev_b32 v10, 4, v10
    v_lshl_add_u32 v10, v8, 9, v10
    s_and_b32 s54, s49, 2
    s_lshl_b32 s54, s54, 11
    v_add_u32 v10, s54, v10
    s_lshl3_add_u32 s54, s44, s50
    s_lshl3_add_u32 s54, s54, s49
    s_lshl_b32 s54, s54, 13
    s_lshl_b32 s55, s51, 7
    s_add_u32 s54, s54, s55
    v_lshlrev_b32 v3, 10, v3
    v_lshl_add_u32 v11, v8, 4, v3
    s_mov_b32 s58, 0
    s_waitcnt vmcnt(0)
L_fin2:
    s_barrier
    ds_read_b128 v[32:35], v10 offset:0
    ds_read_b128 v[36:39], v10 offset:256
    ds_read_b128 v[40:43], v10 offset:8192
    ds_read_b128 v[44:47], v10 offset:8448
    ds_read_b128 v[48:51], v10 offset:16384
    ds_read_b128 v[52:55], v10 offset:16640
    ds_read_b128 v[56:59], v10 offset:24576
    ds_read_b128 v[60:63], v10 offset:24832
    v_add_u32 v10, 0x8000, v10
    s_cmp_eq_u32 s58, 0
    s_mov_b32 s58, 1
    s_waitcnt lgkmcnt(4)
    v_pk_add_f32 v[32:33], v[32:33], v[40:41]
    v_pk_add_f32 v[34:35], v[34:35], v[42:43]
    v_pk_add_f32 v[36:37], v[36:37], v[44:45]
    v_pk_add_f32 v[38:39], v[38:39], v[46:47]
    s_waitcnt lgkmcnt(2)
    v_pk_add_f32 v[32:33], v[32:33], v[48:49]
    v_pk_add_f32 v[34:35], v[34:35], v[50:51]
    v_pk_add_f32 v[36:37], v[36:37], v[52:53]
    v_pk_add_f32 v[38:39], v[38:39], v[54:55]
    s_waitcnt lgkmcnt(0)
    v_pk_add_f32 v[32:33], v[32:33], v[56:57]
    v_pk_add_f32 v[34:35], v[34:35], v[58:59]
    v_pk_add_f32 v[36:37], v[36:37], v[60:61]
    v_pk_add_f32 v[38:39], v[38:39], v[62:63]
    v_cvt_pk_bf16_f32 v64, v32, v33
    v_cvt_pk_bf16_f32 v65, v34, v35
    v_cvt_pk_bf16_f32 v66, v36, v37
    v_cvt_pk_bf16_f32 v67, v38, v39
    buffer_store_dwordx4 v[64:67], v11, s[36:39], s54 offen sc1
    v_add_u32 v11, 0x8000, v11
    s_cbranch_scc1 L_fin2
    s_endpgm
L_spB14:
    s_load_dwordx2 s[20:21], s[18:19], 66560 glc
    s_load_dwordx2 s[22:23], s[18:19], 66688 glc
    s_load_dwordx2 s[24:25], s[18:19], 66816 glc
    s_load_dwordx2 s[26:27], s[18:19], 66944 glc
    s_load_dwordx2 s[40:41], s[18:19], 67072 glc
    s_load_dwordx2 s[42:43], s[18:19], 67200 glc
    s_load_dwordx2 s[14:15], s[18:19], 67328 glc
    s_waitcnt lgkmcnt(0)
    s_xor_b64 s[20:21], s[20:21], s[52:53]
    s_xor_b64 s[22:23], s[22:23], s[52:53]
    s_xor_b64 s[24:25], s[24:25], s[52:53]
    s_xor_b64 s[26:27], s[26:27], s[52:53]
    s_xor_b64 s[40:41], s[40:41], s[52:53]
    s_xor_b64 s[42:43], s[42:43], s[52:53]
    s_xor_b64 s[14:15], s[14:15], s[52:53]
    s_or_b64 s[20:21], s[20:21], s[22:23]
    s_or_b64 s[24:25], s[24:25], s[26:27]
    s_or_b64 s[40:41], s[40:41], s[42:43]
    s_or_b64 s[20:21], s[20:21], s[24:25]
    s_or_b64 s[40:41], s[40:41], s[14:15]
    s_or_b64 s[20:21], s[20:21], s[40:41]
    s_cbranch_scc0 L_spB14x
    s_add_u32 s58, s58, 1
    s_cmp_lt_u32 s58, 0x400000
    s_cbranch_scc1 L_spB14
    s_branch L_spB14x
    .p2align 12
L_cwave:
    s_setprio 1
    s_cmp_eq_u32 s47, 7
    s_cbranch_scc1 L_cidle
    s_and_b32 s64, s49, 1
    s_mul_i32 s60, s45, 7
    s_add_u32 s60, s60, s47
    s_lshl1_add_u32 s60, s60, s64
    s_lshl_b32 s54, s60, 7
    s_waitcnt lgkmcnt(0)
    s_add_u32 s18, s8, s54
    s_addc_u32 s19, s9, 0
    s_load_dwordx8 s[20:27], s[18:19], 0
    s_load_dwordx8 s[28:35], s[18:19], 32
    s_load_dwordx8 s[36:43], s[18:19], 64
    s_load_dwordx8 s[4:11], s[18:19], 96
    s_lshl_b32 s56, s44, 17
    s_add_u32 s56, s56, 8388608
    s_add_u32 s62, s16, s56
    s_addc_u32 s63, s17, 0
    s_load_dwordx2 s[52:53], s[62:63], 0
    s_cmp_eq_u32 s49, 0
    s_cbranch_scc1 L_stub1
    s_cmp_eq_u32 s49, 1
    s_cbranch_scc1 L_stub3
L_touched:
    s_lshl_b32 s50, s45, 2
    s_add_u32 s50, s50, s46
    s_and_b32 s56, s2, 7
    s_lshl_b32 s56, s56, 2
    s_lshr_b32 s56, 0x10210210, s56
    s_cmp_ge_u32 s46, 2
    s_cselect_b32 s56, 7, s56
    s_lshl_b32 s57, s46, 2
    s_add_u32 s56, s56, s57
    s_add_u32 s51, s56, s47
    s_add_u32 s51, s51, 1
    s_and_b32 s51, s51, 7
    s_lshr_b32 s65, s49, 1
    v_lshrrev_b32 v3, 4, v2
    v_bfe_u32 v4, v2, 2, 2
    v_lshl_add_u32 v5, v3, 3, v4
    v_lshlrev_b32 v5, 8, v5
    v_bfe_u32 v4, v2, 2, 3
    s_lshl_b32 s54, s64, 2
    v_xor_b32 v4, s54, v4
    v_lshl_add_u32 v5, v4, 5, v5
    v_and_b32 v4, 3, v2
    v_lshl_add_u32 v5, v4, 3, v5
    v_add_u32 v10, 16384, v5
    v_xor_b32 v11, 32, v10
    v_xor_b32 v12, 64, v10
    v_xor_b32 v13, 96, v10
    v_and_b32 v4, 15, v2
    v_bfe_u32 v5, v2, 1, 3
    v_xor_b32 v5, v5, v3
    v_lshlrev_b32 v4, 7, v4
    v_lshl_add_u32 v4, v5, 4, v4
    s_lshl_b32 s54, s65, 13
    v_add_u32 v14, s54, v4
    v_xor_b32 v15, 64, v14
    s_lshl1_add_u32 s54, s46, s65
    s_mul_i32 s54, s54, 28
    s_add_u32 s54, s54, s60
    s_lshl_b32 s55, s54, 7
    v_lshl_add_u32 v24, v2, 4, s55
    v_add_u32 v25, 0x8000, v24
    v_add_u32 v26, 0x10000, v24
    s_mul_i32 s55, s44, 224
    s_add_u32 s54, s54, s55
    s_lshl_b32 s54, s54, 13
    v_lshl_add_u32 v16, v2, 4, s54
    v_add_u32 v17, 4096, v16
    v_mov_b32 v4, 3243245568
    v_mov_b32 v5, v4
    s_mov_b32 s58, 0
    s_mov_b32 s59, 0
    s_mov_b32 s61, 32768
    s_waitcnt lgkmcnt(0)
    v_mov_b32 v192, s20
    v_mov_b32 v193, s21
    v_mov_b32 v194, s28
    v_mov_b32 v195, s29
    v_mov_b32 v196, s36
    v_mov_b32 v197, s37
    v_mov_b32 v198, s4
    v_mov_b32 v199, s5
    s_lshl_b64 exec, exec, 16
    v_mov_b32 v192, s22
    v_mov_b32 v193, s23
    v_mov_b32 v194, s30
    v_mov_b32 v195, s31
    v_mov_b32 v196, s38
    v_mov_b32 v197, s39
    v_mov_b32 v198, s6
    v_mov_b32 v199, s7
    s_lshl_b64 exec, exec, 16
    v_mov_b32 v192, s24
    v_mov_b32 v193, s25
    v_mov_b32 v194, s32
    v_mov_b32 v195, s33
    v_mov_b32 v196, s40
    v_mov_b32 v197, s41
    v_mov_b32 v198, s8
    v_mov_b32 v199, s9
    s_lshl_b64 exec, exec, 16
    v_mov_b32 v192, s26
    v_mov_b32 v193, s27
    v_mov_b32 v194, s34
    v_mov_b32 v195, s35
    v_mov_b32 v196, s42
    v_mov_b32 v197, s43
    v_mov_b32 v198, s10
    v_mov_b32 v199, s11
    s_mov_b64 exec, -1
    v_lshlrev_b32 v64, 16, v192
    v_and_b32 v65, 0xffff0000, v192
    v_lshlrev_b32 v66, 16, v193
    v_and_b32 v67, 0xffff0000, v193
    v_mov_b64 v[72:73], v[64:65]
    v_mov_b64 v[74:75], v[66:67]
    v_mov_b64 v[80:81], v[64:65]
    v_mov_b64 v[82:83], v[66:67]
    v_mov_b64 v[88:89], v[64:65]
    v_mov_b64 v[90:91], v[66:67]
    v_lshlrev_b32 v68, 16, v194
    v_and_b32 v69, 0xffff0000, v194
    v_lshlrev_b32 v70, 16, v195
    v_and_b32 v71, 0xffff0000, v195
    v_mov_b64 v[76:77], v[68:69]
    v_mov_b64 v[78:79], v[70:71]
    v_mov_b64 v[84:85], v[68:69]
    v_mov_b64 v[86:87], v[70:71]
    v_mov_b64 v[92:93], v[68:69]
    v_mov_b64 v[94:95], v[70:71]
    v_lshlrev_b32 v96, 16, v196
    v_and_b32 v97, 0xffff0000, v196
    v_lshlrev_b32 v98, 16, v197
    v_and_b32 v99, 0xffff0000, v197
    v_mov_b64 v[104:105], v[96:97]
    v_mov_b64 v[106:107], v[98:99]
    v_mov_b64 v[112:113], v[96:97]
    v_mov_b64 v[114:115], v[98:99]
    v_mov_b64 v[120:121], v[96:97]
    v_mov_b64 v[122:123], v[98:99]
    v_lshlrev_b32 v100, 16, v198
    v_and_b32 v101, 0xffff0000, v198
    v_lshlrev_b32 v102, 16, v199
    v_and_b32 v103, 0xffff0000, v199
    v_mov_b64 v[108:109], v[100:101]
    v_mov_b64 v[110:111], v[102:103]
    v_mov_b64 v[116:117], v[100:101]
    v_mov_b64 v[118:119], v[102:103]
    v_mov_b64 v[124:125], v[100:101]
    v_mov_b64 v[126:127], v[102:103]
    s_mov_b32 s4, 1069066811
    s_mov_b32 s5, s4
    s_mov_b32 s6, 964689920
    s_mov_b32 s7, s6
    s_mov_b32 s8, 855638016
    s_mov_b32 s9, s8
    s_mov_b64 s[32:33], s[16:17]
    s_mov_b32 s34, 16777216
    s_mov_b32 s35, 0x20000
    s_add_u32 s52, s52, 2135587861
    s_addc_u32 s53, s53, 2654435769
    v_mov_b32 v20, s52
    v_mov_b32 v21, s53
    v_mov_b32 v22, s52
    v_mov_b32 v23, s53
    s_lshl_b32 s54, s45, 8
    s_and_b32 s55, s2, 0xf8
    s_add_u32 s54, s54, s55
    v_mov_b32 v19, s54
    s_barrier
    ds_read_b128 v[192:195], v14 offset:0
    ds_read_b128 v[196:199], v15 offset:0
    ds_read_b64_tr_b16 v[128:129], v10 offset:0
    ds_read_b64_tr_b16 v[130:131], v10 offset:1024
    ds_read_b64_tr_b16 v[132:133], v10 offset:8192
    ds_read_b64_tr_b16 v[134:135], v10 offset:9216
    ds_read_b64_tr_b16 v[136:137], v11 offset:0
    ds_read_b64_tr_b16 v[138:139], v11 offset:1024
    ds_read_b64_tr_b16 v[140:141], v11 offset:8192
    ds_read_b64_tr_b16 v[142:143], v11 offset:9216
    ds_read_b64_tr_b16 v[144:145], v12 offset:0
    ds_read_b64_tr_b16 v[146:147], v12 offset:1024
    ds_read_b64_tr_b16 v[148:149], v12 offset:8192
    ds_read_b64_tr_b16 v[150:151], v12 offset:9216
    ds_read_b64_tr_b16 v[152:153], v13 offset:0
    ds_read_b64_tr_b16 v[154:155], v13 offset:1024
    ds_read_b64_tr_b16 v[156:157], v13 offset:8192
    ds_read_b64_tr_b16 v[158:159], v13 offset:9216
    ds_read_b128 v[200:203], v14 offset:2048
    ds_read_b128 v[204:207], v15 offset:2048
    s_cmp_lg_u32 s49, 0
    s_cbranch_scc1 L_noalive
    s_mov_b64 exec, 1
    global_store_dwordx2 v19, v[20:21], s[62:63] offset:512 sc1
    s_mov_b64 exec, -1
L_noalive:
    s_branch L_centry
L_cloop:
    s_barrier
    v_mfma_f32_16x16x32_bf16 v[80:83], v[160:163], v[208:211], v[80:83]
    ds_read_b128 v[192:195], v14 offset:0
    ds_read_b128 v[196:199], v15 offset:0
    v_mfma_f32_16x16x32_bf16 v[80:83], v[164:167], v[212:215], v[80:83]
    ds_read_b64_tr_b16 v[128:129], v10 offset:0
    ds_read_b64_tr_b16 v[130:131], v10 offset:1024
    v_mfma_f32_16x16x32_bf16 v[84:87], v[172:175], v[212:215], v[84:87]
    ds_read_b64_tr_b16 v[132:133], v10 offset:8192
    ds_read_b64_tr_b16 v[134:135], v10 offset:9216
    v_mfma_f32_16x16x32_bf16 v[84:87], v[168:171], v[208:211], v[84:87]
    ds_read_b64_tr_b16 v[136:137], v11 offset:0
    ds_read_b64_tr_b16 v[138:139], v11 offset:1024
    v_mfma_f32_16x16x32_bf16 v[112:115], v[176:179], v[208:211], v[112:115]
    ds_read_b64_tr_b16 v[140:141], v11 offset:8192
    ds_read_b64_tr_b16 v[142:143], v11 offset:9216
    v_mfma_f32_16x16x32_bf16 v[112:115], v[180:183], v[212:215], v[112:115]
    ds_read_b64_tr_b16 v[144:145], v12 offset:0
    ds_read_b64_tr_b16 v[146:147], v12 offset:1024
    v_mfma_f32_16x16x32_bf16 v[116:119], v[188:191], v[212:215], v[116:119]
    ds_read_b64_tr_b16 v[148:149], v12 offset:8192
    ds_read_b64_tr_b16 v[150:151], v12 offset:9216
    v_mfma_f32_16x16x32_bf16 v[116:119], v[184:187], v[208:211], v[116:119]
    ds_read_b64_tr_b16 v[152:153], v13 offset:0
    ds_read_b64_tr_b16 v[154:155], v13 offset:1024
    v_mfma_f32_16x16x32_bf16 v[124:127], v[184:187], v[216:219], v[124:127]
    ds_read_b64_tr_b16 v[156:157], v13 offset:8192
    v_mfma_f32_16x16x32_bf16 v[124:127], v[188:191], v[220:223], v[124:127]
    ds_read_b64_tr_b16 v[158:159], v13 offset:9216
    v_mfma_f32_16x16x32_bf16 v[120:123], v[180:183], v[220:223], v[120:123]
    ds_read_b128 v[200:203], v14 offset:2048
    v_mfma_f32_16x16x32_bf16 v[120:123], v[176:179], v[216:219], v[120:123]
    ds_read_b128 v[204:207], v15 offset:2048
    v_mfma_f32_16x16x32_bf16 v[92:95], v[168:171], v[216:219], v[92:95]
    v_mfma_f32_16x16x32_bf16 v[92:95], v[172:175], v[220:223], v[92:95]
    v_mfma_f32_16x16x32_bf16 v[88:91], v[164:167], v[220:223], v[88:91]
    v_mfma_f32_16x16x32_bf16 v[88:91], v[160:163], v[216:219], v[88:91]
L_centry:
    s_add_u32 s59, s59, 1
    s_cmp_eq_u32 s59, 5
    s_cselect_b32 s54, 4294836224, s61
    s_cselect_b32 s59, 0, s59
    s_waitcnt lgkmcnt(14)
    v_mfma_f32_16x16x32_bf16 v[64:67], v[128:131], v[192:195], v[64:67]
    ds_read_b128 v[208:211], v14 offset:4096
    v_mfma_f32_16x16x32_bf16 v[64:67], v[132:135], v[196:199], v[64:67]
    s_waitcnt lgkmcnt(11)
    v_mfma_f32_16x16x32_bf16 v[68:71], v[140:143], v[196:199], v[68:71]
    ds_read_b128 v[212:215], v15 offset:4096
    v_mfma_f32_16x16x32_bf16 v[68:71], v[136:139], v[192:195], v[68:71]
    s_waitcnt lgkmcnt(8)
    v_mfma_f32_16x16x32_bf16 v[96:99], v[144:147], v[192:195], v[96:99]
    ds_read_b128 v[216:219], v14 offset:6144
    v_mfma_f32_16x16x32_bf16 v[96:99], v[148:151], v[196:199], v[96:99]
    s_waitcnt lgkmcnt(5)
    v_mfma_f32_16x16x32_bf16 v[100:103], v[156:159], v[196:199], v[100:103]
    ds_read_b128 v[220:223], v15 offset:6144
    v_mfma_f32_16x16x32_bf16 v[100:103], v[152:155], v[192:195], v[100:103]
    s_waitcnt lgkmcnt(4)
    v_mfma_f32_16x16x32_bf16 v[108:111], v[152:155], v[200:203], v[108:111]
    v_add_u32 v10, s54, v10
    v_mfma_f32_16x16x32_bf16 v[108:111], v[156:159], v[204:207], v[108:111]
    v_add_u32 v11, s54, v11
    v_mfma_f32_16x16x32_bf16 v[104:107], v[148:151], v[204:207], v[104:107]
    v_add_u32 v12, s54, v12
    v_mfma_f32_16x16x32_bf16 v[104:107], v[144:147], v[200:203], v[104:107]
    v_add_u32 v13, s54, v13
    v_mfma_f32_16x16x32_bf16 v[76:79], v[136:139], v[200:203], v[76:79]
    v_add_u32 v14, s54, v14
    v_mfma_f32_16x16x32_bf16 v[76:79], v[140:143], v[204:207], v[76:79]
    v_add_u32 v15, s54, v15
    v_mfma_f32_16x16x32_bf16 v[72:75], v[132:135], v[204:207], v[72:75]
    s_add_u32 s58, s58, 1
    s_cmp_lt_u32 s58, 8
    s_waitcnt lgkmcnt(0)
    v_mfma_f32_16x16x32_bf16 v[72:75], v[128:131], v[200:203], v[72:75]
    s_barrier
    v_mfma_f32_16x16x32_bf16 v[80:83], v[128:131], v[208:211], v[80:83]
    ds_read_b128 v[192:195], v14 offset:0
    ds_read_b128 v[196:199], v15 offset:0
    v_mfma_f32_16x16x32_bf16 v[80:83], v[132:135], v[212:215], v[80:83]
    ds_read_b64_tr_b16 v[160:161], v10 offset:0
    ds_read_b64_tr_b16 v[162:163], v10 offset:1024
    v_mfma_f32_16x16x32_bf16 v[84:87], v[140:143], v[212:215], v[84:87]
    ds_read_b64_tr_b16 v[164:165], v10 offset:8192
    ds_read_b64_tr_b16 v[166:167], v10 offset:9216
    v_mfma_f32_16x16x32_bf16 v[84:87], v[136:139], v[208:211], v[84:87]
    ds_read_b64_tr_b16 v[168:169], v11 offset:0
    ds_read_b64_tr_b16 v[170:171], v11 offset:1024
    v_mfma_f32_16x16x32_bf16 v[112:115], v[144:147], v[208:211], v[112:115]
    ds_read_b64_tr_b16 v[172:173], v11 offset:8192
    ds_read_b64_tr_b16 v[174:175], v11 offset:9216
    v_mfma_f32_16x16x32_bf16 v[112:115], v[148:151], v[212:215], v[112:115]
    ds_read_b64_tr_b16 v[176:177], v12 offset:0
    ds_read_b64_tr_b16 v[178:179], v12 offset:1024
    v_mfma_f32_16x16x32_bf16 v[116:119], v[156:159], v[212:215], v[116:119]
    ds_read_b64_tr_b16 v[180:181], v12 offset:8192
    ds_read_b64_tr_b16 v[182:183], v12 offset:9216
    v_mfma_f32_16x16x32_bf16 v[116:119], v[152:155], v[208:211], v[116:119]
    ds_read_b64_tr_b16 v[184:185], v13 offset:0
    ds_read_b64_tr_b16 v[186:187], v13 offset:1024
    v_mfma_f32_16x16x32_bf16 v[124:127], v[152:155], v[216:219], v[124:127]
    ds_read_b64_tr_b16 v[188:189], v13 offset:8192
    v_mfma_f32_16x16x32_bf16 v[124:127], v[156:159], v[220:223], v[124:127]
    ds_read_b64_tr_b16 v[190:191], v13 offset:9216
    v_mfma_f32_16x16x32_bf16 v[120:123], v[148:151], v[220:223], v[120:123]
    ds_read_b128 v[200:203], v14 offset:2048
    v_mfma_f32_16x16x32_bf16 v[120:123], v[144:147], v[216:219], v[120:123]
    ds_read_b128 v[204:207], v15 offset:2048
    v_mfma_f32_16x16x32_bf16 v[92:95], v[136:139], v[216:219], v[92:95]
    v_mfma_f32_16x16x32_bf16 v[92:95], v[140:143], v[220:223], v[92:95]
    v_mfma_f32_16x16x32_bf16 v[88:91], v[132:135], v[220:223], v[88:91]
    v_mfma_f32_16x16x32_bf16 v[88:91], v[128:131], v[216:219], v[88:91]
    s_add_u32 s59, s59, 1
    s_cmp_eq_u32 s59, 5
    s_cselect_b32 s54, 4294836224, s61
    s_cselect_b32 s59, 0, s59
    s_waitcnt lgkmcnt(14)
    v_mfma_f32_16x16x32_bf16 v[64:67], v[160:163], v[192:195], v[64:67]
    ds_read_b128 v[208:211], v14 offset:4096
    v_mfma_f32_16x16x32_bf16 v[64:67], v[164:167], v[196:199], v[64:67]
    s_waitcnt lgkmcnt(11)
    v_mfma_f32_16x16x32_bf16 v[68:71], v[172:175], v[196:199], v[68:71]
    ds_read_b128 v[212:215], v15 offset:4096
    v_mfma_f32_16x16x32_bf16 v[68:71], v[168:171], v[192:195], v[68:71]
    s_waitcnt lgkmcnt(8)
    v_mfma_f32_16x16x32_bf16 v[96:99], v[176:179], v[192:195], v[96:99]
    ds_read_b128 v[216:219], v14 offset:6144
    v_mfma_f32_16x16x32_bf16 v[96:99], v[180:183], v[196:199], v[96:99]
    s_waitcnt lgkmcnt(5)
    v_mfma_f32_16x16x32_bf16 v[100:103], v[188:191], v[196:199], v[100:103]
    ds_read_b128 v[220:223], v15 offset:6144
    v_mfma_f32_16x16x32_bf16 v[100:103], v[184:187], v[192:195], v[100:103]
    s_waitcnt lgkmcnt(4)
    v_mfma_f32_16x16x32_bf16 v[108:111], v[184:187], v[200:203], v[108:111]
    v_add_u32 v10, s54, v10
    v_mfma_f32_16x16x32_bf16 v[108:111], v[188:191], v[204:207], v[108:111]
    v_add_u32 v11, s54, v11
    v_mfma_f32_16x16x32_bf16 v[104:107], v[180:183], v[204:207], v[104:107]
    v_add_u32 v12, s54, v12
    v_mfma_f32_16x16x32_bf16 v[104:107], v[176:179], v[200:203], v[104:107]
    v_add_u32 v13, s54, v13
    v_mfma_f32_16x16x32_bf16 v[76:79], v[168:171], v[200:203], v[76:79]
    v_add_u32 v14, s54, v14
    v_mfma_f32_16x16x32_bf16 v[76:79], v[172:175], v[204:207], v[76:79]
    v_add_u32 v15, s54, v15
    v_mfma_f32_16x16x32_bf16 v[72:75], v[164:167], v[204:207], v[72:75]
    s_add_u32 s58, s58, 1
    s_cmp_lt_u32 s58, 8
    s_waitcnt lgkmcnt(0)
    v_mfma_f32_16x16x32_bf16 v[72:75], v[160:163], v[200:203], v[72:75]
    s_cbranch_scc1 L_cloop
    s_barrier
    s_branch L_epi
L_cidle:
    s_cmp_lt_u32 s49, 2
    s_cbranch_scc1 L_nocpf
    s_getpc_b64 s[42:43]
L_pc:
    s_sub_u32 s42, s42, L_pc-standalone__dense_activation_mish__prompt_kernel
    s_subb_u32 s43, s43, 0
    v_and_b32 v31, 127, v0
    v_min_u32 v31, (L_end-standalone__dense_activation_mish__prompt_kernel)/128, v31
    v_lshlrev_b32 v31, 7, v31
    global_load_dword v31, v31, s[42:43]
L_nocpf:
    s_lshl_b32 s50, s45, 2
    s_add_u32 s50, s50, s46
    s_and_b32 s56, s2, 7
    s_lshl_b32 s56, s56, 2
    s_lshr_b32 s56, 0x10210210, s56
    s_cmp_ge_u32 s46, 2
    s_cselect_b32 s56, 7, s56
    s_lshl_b32 s57, s46, 2
    s_add_u32 s56, s56, s57
    s_add_u32 s51, s56, s47
    s_add_u32 s51, s51, 1
    s_and_b32 s51, s51, 7
    s_waitcnt lgkmcnt(0)
    s_lshl_b32 s56, s44, 17
    s_add_u32 s56, s56, 8388608
    s_add_u32 s62, s16, s56
    s_addc_u32 s63, s17, 0
    s_load_dwordx2 s[52:53], s[62:63], 0
    s_mov_b64 s[32:33], s[16:17]
    s_mov_b32 s34, 16777216
    s_mov_b32 s35, 0x20000
    s_mov_b64 s[28:29], s[10:11]
    s_mov_b32 s30, 1835008
    s_mov_b32 s31, 0x20000
    v_and_b32 v3, 31, v2
    v_lshrrev_b32 v6, 5, v2
    v_lshl_add_u32 v3, v6, 6, v3
    v_lshlrev_b32 v3, 10, v3
    s_lshl2_add_u32 s57, s46, s49
    s_lshl_b32 s57, s57, 17
    s_add_u32 s57, s57, 33152
    s_waitcnt lgkmcnt(0)
    s_add_u32 s52, s52, 2135587861
    s_addc_u32 s53, s53, 2654435769
    v_mov_b32 v20, s52
    v_mov_b32 v21, s53
    v_mov_b32 v22, s52
    v_mov_b32 v23, s53
    s_lshl_b32 s54, s45, 8
    s_and_b32 s55, s2, 0xf8
    s_add_u32 s54, s54, s55
    v_mov_b32 v19, s54
    s_barrier
    buffer_load_dword v28, v3, s[28:31], s57 offen
    s_cmp_lg_u32 s49, 0
    s_cbranch_scc1 L_cid2
    s_mov_b64 exec, 1
    global_store_dwordx2 v19, v[20:21], s[62:63] offset:512 sc1
    s_mov_b64 exec, -1
L_cid2:
    s_cmp_lg_u32 s49, 1
    s_cbranch_scc1 L_dryx
    s_mov_b32 s34, 0
    v_mov_b32 v16, 0
    v_mov_b32 v17, 0
    s_branch L_epi
L_dryx:
    s_mov_b32 s34, 16777216
    s_branch L_final
    .p2align 12
L_stub3:
    s_branch L_touched
L_epi:
    v_mfma_f32_16x16x32_bf16 v[80:83], v[160:163], v[208:211], v[80:83]
    v_mfma_f32_16x16x32_bf16 v[80:83], v[164:167], v[212:215], v[80:83]
    v_mfma_f32_16x16x32_bf16 v[84:87], v[168:171], v[208:211], v[84:87]
    v_mfma_f32_16x16x32_bf16 v[84:87], v[172:175], v[212:215], v[84:87]
    v_mfma_f32_16x16x32_bf16 v[88:91], v[160:163], v[216:219], v[88:91]
    v_mfma_f32_16x16x32_bf16 v[88:91], v[164:167], v[220:223], v[88:91]
    v_mfma_f32_16x16x32_bf16 v[92:95], v[168:171], v[216:219], v[92:95]
    v_mfma_f32_16x16x32_bf16 v[92:95], v[172:175], v[220:223], v[92:95]
    v_mfma_f32_16x16x32_bf16 v[112:115], v[176:179], v[208:211], v[112:115]
    v_mfma_f32_16x16x32_bf16 v[112:115], v[180:183], v[212:215], v[112:115]
    v_mfma_f32_16x16x32_bf16 v[116:119], v[184:187], v[208:211], v[116:119]
    v_mfma_f32_16x16x32_bf16 v[116:119], v[188:191], v[212:215], v[116:119]
    v_mfma_f32_16x16x32_bf16 v[120:123], v[176:179], v[216:219], v[120:123]
    v_mfma_f32_16x16x32_bf16 v[120:123], v[180:183], v[220:223], v[120:123]
    v_mfma_f32_16x16x32_bf16 v[124:127], v[184:187], v[216:219], v[124:127]
    v_mfma_f32_16x16x32_bf16 v[124:127], v[188:191], v[220:223], v[124:127]
    s_cmp_eq_u32 s47, 7
    v_pk_fma_f32 v[192:193], v[64:65], s[4:5], v[4:5]
    v_pk_fma_f32 v[194:195], v[66:67], s[4:5], v[4:5]
    v_pk_fma_f32 v[196:197], v[68:69], s[4:5], v[4:5]
    v_pk_fma_f32 v[198:199], v[70:71], s[4:5], v[4:5]
    v_exp_f32 v192, v192 clamp
    v_exp_f32 v193, v193 clamp
    v_exp_f32 v194, v194 clamp
    v_exp_f32 v195, v195 clamp
    v_exp_f32 v196, v196 clamp
    v_exp_f32 v197, v197 clamp
    v_exp_f32 v198, v198 clamp
    v_exp_f32 v199, v199 clamp
    v_pk_add_f32 v[200:201], v[192:193], s[6:7]
    v_pk_add_f32 v[202:203], v[194:195], s[6:7]
    v_pk_add_f32 v[204:205], v[196:197], s[6:7]
    v_pk_add_f32 v[206:207], v[198:199], s[6:7]
    v_pk_fma_f32 v[224:225], v[192:193], v[200:201], s[8:9]
    v_pk_fma_f32 v[226:227], v[194:195], v[202:203], s[8:9]
    v_pk_fma_f32 v[228:229], v[196:197], v[204:205], s[8:9]
    v_pk_fma_f32 v[230:231], v[198:199], v[206:207], s[8:9]
    v_rcp_f32 v224, v224
    v_rcp_f32 v225, v225
    v_rcp_f32 v226, v226
    v_rcp_f32 v227, v227
    v_rcp_f32 v228, v228
    v_rcp_f32 v229, v229
    v_rcp_f32 v230, v230
    v_rcp_f32 v231, v231
    v_pk_mul_f32 v[224:225], v[224:225], v[192:193]
    v_pk_mul_f32 v[226:227], v[226:227], v[194:195]
    v_pk_mul_f32 v[228:229], v[228:229], v[196:197]
    v_pk_mul_f32 v[230:231], v[230:231], v[198:199]
    v_pk_mul_f32 v[224:225], v[224:225], v[200:201]
    v_pk_mul_f32 v[226:227], v[226:227], v[202:203]
    v_pk_mul_f32 v[228:229], v[228:229], v[204:205]
    v_pk_mul_f32 v[230:231], v[230:231], v[206:207]
    v_pk_mul_f32 v[192:193], v[224:225], v[64:65]
    v_pk_mul_f32 v[194:195], v[226:227], v[66:67]
    v_pk_mul_f32 v[196:197], v[228:229], v[68:69]
    v_pk_mul_f32 v[198:199], v[230:231], v[70:71]
    v_cvt_pk_bf16_f32 v128, v192, v193
    v_cvt_pk_bf16_f32 v129, v194, v195
    v_cvt_pk_bf16_f32 v130, v196, v197
    v_cvt_pk_bf16_f32 v131, v198, v199
    buffer_store_dwordx4 v[128:131], v16, s[32:35], 0 offen offset:0 sc1
    v_pk_fma_f32 v[192:193], v[72:73], s[4:5], v[4:5]
    v_pk_fma_f32 v[194:195], v[74:75], s[4:5], v[4:5]
    v_pk_fma_f32 v[196:197], v[76:77], s[4:5], v[4:5]
    v_pk_fma_f32 v[198:199], v[78:79], s[4:5], v[4:5]
    v_exp_f32 v192, v192 clamp
    v_exp_f32 v193, v193 clamp
    v_exp_f32 v194, v194 clamp
    v_exp_f32 v195, v195 clamp
    v_exp_f32 v196, v196 clamp
    v_exp_f32 v197, v197 clamp
    v_exp_f32 v198, v198 clamp
    v_exp_f32 v199, v199 clamp
    v_pk_add_f32 v[200:201], v[192:193], s[6:7]
    v_pk_add_f32 v[202:203], v[194:195], s[6:7]
    v_pk_add_f32 v[204:205], v[196:197], s[6:7]
    v_pk_add_f32 v[206:207], v[198:199], s[6:7]
    v_pk_fma_f32 v[224:225], v[192:193], v[200:201], s[8:9]
    v_pk_fma_f32 v[226:227], v[194:195], v[202:203], s[8:9]
    v_pk_fma_f32 v[228:229], v[196:197], v[204:205], s[8:9]
    v_pk_fma_f32 v[230:231], v[198:199], v[206:207], s[8:9]
    v_rcp_f32 v224, v224
    v_rcp_f32 v225, v225
    v_rcp_f32 v226, v226
    v_rcp_f32 v227, v227
    v_rcp_f32 v228, v228
    v_rcp_f32 v229, v229
    v_rcp_f32 v230, v230
    v_rcp_f32 v231, v231
    v_pk_mul_f32 v[224:225], v[224:225], v[192:193]
    v_pk_mul_f32 v[226:227], v[226:227], v[194:195]
    v_pk_mul_f32 v[228:229], v[228:229], v[196:197]
    v_pk_mul_f32 v[230:231], v[230:231], v[198:199]
    v_pk_mul_f32 v[224:225], v[224:225], v[200:201]
    v_pk_mul_f32 v[226:227], v[226:227], v[202:203]
    v_pk_mul_f32 v[228:229], v[228:229], v[204:205]
    v_pk_mul_f32 v[230:231], v[230:231], v[206:207]
    v_pk_mul_f32 v[192:193], v[224:225], v[72:73]
    v_pk_mul_f32 v[194:195], v[226:227], v[74:75]
    v_pk_mul_f32 v[196:197], v[228:229], v[76:77]
    v_pk_mul_f32 v[198:199], v[230:231], v[78:79]
    v_cvt_pk_bf16_f32 v132, v192, v193
    v_cvt_pk_bf16_f32 v133, v194, v195
    v_cvt_pk_bf16_f32 v134, v196, v197
    v_cvt_pk_bf16_f32 v135, v198, v199
    buffer_store_dwordx4 v[132:135], v16, s[32:35], 0 offen offset:1024 sc1
    v_pk_fma_f32 v[192:193], v[80:81], s[4:5], v[4:5]
    v_pk_fma_f32 v[194:195], v[82:83], s[4:5], v[4:5]
    v_pk_fma_f32 v[196:197], v[84:85], s[4:5], v[4:5]
    v_pk_fma_f32 v[198:199], v[86:87], s[4:5], v[4:5]
    v_exp_f32 v192, v192 clamp
    v_exp_f32 v193, v193 clamp
    v_exp_f32 v194, v194 clamp
    v_exp_f32 v195, v195 clamp
    v_exp_f32 v196, v196 clamp
    v_exp_f32 v197, v197 clamp
    v_exp_f32 v198, v198 clamp
    v_exp_f32 v199, v199 clamp
    v_pk_add_f32 v[200:201], v[192:193], s[6:7]
    v_pk_add_f32 v[202:203], v[194:195], s[6:7]
    v_pk_add_f32 v[204:205], v[196:197], s[6:7]
    v_pk_add_f32 v[206:207], v[198:199], s[6:7]
    v_pk_fma_f32 v[224:225], v[192:193], v[200:201], s[8:9]
    v_pk_fma_f32 v[226:227], v[194:195], v[202:203], s[8:9]
    v_pk_fma_f32 v[228:229], v[196:197], v[204:205], s[8:9]
    v_pk_fma_f32 v[230:231], v[198:199], v[206:207], s[8:9]
    v_rcp_f32 v224, v224
    v_rcp_f32 v225, v225
    v_rcp_f32 v226, v226
    v_rcp_f32 v227, v227
    v_rcp_f32 v228, v228
    v_rcp_f32 v229, v229
    v_rcp_f32 v230, v230
    v_rcp_f32 v231, v231
    v_pk_mul_f32 v[224:225], v[224:225], v[192:193]
    v_pk_mul_f32 v[226:227], v[226:227], v[194:195]
    v_pk_mul_f32 v[228:229], v[228:229], v[196:197]
    v_pk_mul_f32 v[230:231], v[230:231], v[198:199]
    v_pk_mul_f32 v[224:225], v[224:225], v[200:201]
    v_pk_mul_f32 v[226:227], v[226:227], v[202:203]
    v_pk_mul_f32 v[228:229], v[228:229], v[204:205]
    v_pk_mul_f32 v[230:231], v[230:231], v[206:207]
    v_pk_mul_f32 v[192:193], v[224:225], v[80:81]
    v_pk_mul_f32 v[194:195], v[226:227], v[82:83]
    v_pk_mul_f32 v[196:197], v[228:229], v[84:85]
    v_pk_mul_f32 v[198:199], v[230:231], v[86:87]
    v_cvt_pk_bf16_f32 v136, v192, v193
    v_cvt_pk_bf16_f32 v137, v194, v195
    v_cvt_pk_bf16_f32 v138, v196, v197
    v_cvt_pk_bf16_f32 v139, v198, v199
    buffer_store_dwordx4 v[136:139], v16, s[32:35], 0 offen offset:2048 sc1
    v_pk_fma_f32 v[192:193], v[88:89], s[4:5], v[4:5]
    v_pk_fma_f32 v[194:195], v[90:91], s[4:5], v[4:5]
    v_pk_fma_f32 v[196:197], v[92:93], s[4:5], v[4:5]
    v_pk_fma_f32 v[198:199], v[94:95], s[4:5], v[4:5]
    v_exp_f32 v192, v192 clamp
    v_exp_f32 v193, v193 clamp
    v_exp_f32 v194, v194 clamp
    v_exp_f32 v195, v195 clamp
    v_exp_f32 v196, v196 clamp
    v_exp_f32 v197, v197 clamp
    v_exp_f32 v198, v198 clamp
    v_exp_f32 v199, v199 clamp
    v_pk_add_f32 v[200:201], v[192:193], s[6:7]
    v_pk_add_f32 v[202:203], v[194:195], s[6:7]
    v_pk_add_f32 v[204:205], v[196:197], s[6:7]
    v_pk_add_f32 v[206:207], v[198:199], s[6:7]
    v_pk_fma_f32 v[224:225], v[192:193], v[200:201], s[8:9]
    v_pk_fma_f32 v[226:227], v[194:195], v[202:203], s[8:9]
    v_pk_fma_f32 v[228:229], v[196:197], v[204:205], s[8:9]
    v_pk_fma_f32 v[230:231], v[198:199], v[206:207], s[8:9]
    v_rcp_f32 v224, v224
    v_rcp_f32 v225, v225
    v_rcp_f32 v226, v226
    v_rcp_f32 v227, v227
    v_rcp_f32 v228, v228
    v_rcp_f32 v229, v229
    v_rcp_f32 v230, v230
    v_rcp_f32 v231, v231
    v_pk_mul_f32 v[224:225], v[224:225], v[192:193]
    v_pk_mul_f32 v[226:227], v[226:227], v[194:195]
    v_pk_mul_f32 v[228:229], v[228:229], v[196:197]
    v_pk_mul_f32 v[230:231], v[230:231], v[198:199]
    v_pk_mul_f32 v[224:225], v[224:225], v[200:201]
    v_pk_mul_f32 v[226:227], v[226:227], v[202:203]
    v_pk_mul_f32 v[228:229], v[228:229], v[204:205]
    v_pk_mul_f32 v[230:231], v[230:231], v[206:207]
    v_pk_mul_f32 v[192:193], v[224:225], v[88:89]
    v_pk_mul_f32 v[194:195], v[226:227], v[90:91]
    v_pk_mul_f32 v[196:197], v[228:229], v[92:93]
    v_pk_mul_f32 v[198:199], v[230:231], v[94:95]
    v_cvt_pk_bf16_f32 v140, v192, v193
    v_cvt_pk_bf16_f32 v141, v194, v195
    v_cvt_pk_bf16_f32 v142, v196, v197
    v_cvt_pk_bf16_f32 v143, v198, v199
    buffer_store_dwordx4 v[140:143], v16, s[32:35], 0 offen offset:3072 sc1
    v_pk_fma_f32 v[192:193], v[96:97], s[4:5], v[4:5]
    v_pk_fma_f32 v[194:195], v[98:99], s[4:5], v[4:5]
    v_pk_fma_f32 v[196:197], v[100:101], s[4:5], v[4:5]
    v_pk_fma_f32 v[198:199], v[102:103], s[4:5], v[4:5]
    v_exp_f32 v192, v192 clamp
    v_exp_f32 v193, v193 clamp
    v_exp_f32 v194, v194 clamp
    v_exp_f32 v195, v195 clamp
    v_exp_f32 v196, v196 clamp
    v_exp_f32 v197, v197 clamp
    v_exp_f32 v198, v198 clamp
    v_exp_f32 v199, v199 clamp
    v_pk_add_f32 v[200:201], v[192:193], s[6:7]
    v_pk_add_f32 v[202:203], v[194:195], s[6:7]
    v_pk_add_f32 v[204:205], v[196:197], s[6:7]
    v_pk_add_f32 v[206:207], v[198:199], s[6:7]
    v_pk_fma_f32 v[224:225], v[192:193], v[200:201], s[8:9]
    v_pk_fma_f32 v[226:227], v[194:195], v[202:203], s[8:9]
    v_pk_fma_f32 v[228:229], v[196:197], v[204:205], s[8:9]
    v_pk_fma_f32 v[230:231], v[198:199], v[206:207], s[8:9]
    v_rcp_f32 v224, v224
    v_rcp_f32 v225, v225
    v_rcp_f32 v226, v226
    v_rcp_f32 v227, v227
    v_rcp_f32 v228, v228
    v_rcp_f32 v229, v229
    v_rcp_f32 v230, v230
    v_rcp_f32 v231, v231
    v_pk_mul_f32 v[224:225], v[224:225], v[192:193]
    v_pk_mul_f32 v[226:227], v[226:227], v[194:195]
    v_pk_mul_f32 v[228:229], v[228:229], v[196:197]
    v_pk_mul_f32 v[230:231], v[230:231], v[198:199]
    v_pk_mul_f32 v[224:225], v[224:225], v[200:201]
    v_pk_mul_f32 v[226:227], v[226:227], v[202:203]
    v_pk_mul_f32 v[228:229], v[228:229], v[204:205]
    v_pk_mul_f32 v[230:231], v[230:231], v[206:207]
    v_pk_mul_f32 v[192:193], v[224:225], v[96:97]
    v_pk_mul_f32 v[194:195], v[226:227], v[98:99]
    v_pk_mul_f32 v[196:197], v[228:229], v[100:101]
    v_pk_mul_f32 v[198:199], v[230:231], v[102:103]
    v_cvt_pk_bf16_f32 v144, v192, v193
    v_cvt_pk_bf16_f32 v145, v194, v195
    v_cvt_pk_bf16_f32 v146, v196, v197
    v_cvt_pk_bf16_f32 v147, v198, v199
    buffer_store_dwordx4 v[144:147], v17, s[32:35], 0 offen offset:0 sc1
    v_pk_fma_f32 v[192:193], v[104:105], s[4:5], v[4:5]
    v_pk_fma_f32 v[194:195], v[106:107], s[4:5], v[4:5]
    v_pk_fma_f32 v[196:197], v[108:109], s[4:5], v[4:5]
    v_pk_fma_f32 v[198:199], v[110:111], s[4:5], v[4:5]
    v_exp_f32 v192, v192 clamp
    v_exp_f32 v193, v193 clamp
    v_exp_f32 v194, v194 clamp
    v_exp_f32 v195, v195 clamp
    v_exp_f32 v196, v196 clamp
    v_exp_f32 v197, v197 clamp
    v_exp_f32 v198, v198 clamp
    v_exp_f32 v199, v199 clamp
    v_pk_add_f32 v[200:201], v[192:193], s[6:7]
    v_pk_add_f32 v[202:203], v[194:195], s[6:7]
    v_pk_add_f32 v[204:205], v[196:197], s[6:7]
    v_pk_add_f32 v[206:207], v[198:199], s[6:7]
    v_pk_fma_f32 v[224:225], v[192:193], v[200:201], s[8:9]
    v_pk_fma_f32 v[226:227], v[194:195], v[202:203], s[8:9]
    v_pk_fma_f32 v[228:229], v[196:197], v[204:205], s[8:9]
    v_pk_fma_f32 v[230:231], v[198:199], v[206:207], s[8:9]
    v_rcp_f32 v224, v224
    v_rcp_f32 v225, v225
    v_rcp_f32 v226, v226
    v_rcp_f32 v227, v227
    v_rcp_f32 v228, v228
    v_rcp_f32 v229, v229
    v_rcp_f32 v230, v230
    v_rcp_f32 v231, v231
    v_pk_mul_f32 v[224:225], v[224:225], v[192:193]
    v_pk_mul_f32 v[226:227], v[226:227], v[194:195]
    v_pk_mul_f32 v[228:229], v[228:229], v[196:197]
    v_pk_mul_f32 v[230:231], v[230:231], v[198:199]
    v_pk_mul_f32 v[224:225], v[224:225], v[200:201]
    v_pk_mul_f32 v[226:227], v[226:227], v[202:203]
    v_pk_mul_f32 v[228:229], v[228:229], v[204:205]
    v_pk_mul_f32 v[230:231], v[230:231], v[206:207]
    v_pk_mul_f32 v[192:193], v[224:225], v[104:105]
    v_pk_mul_f32 v[194:195], v[226:227], v[106:107]
    v_pk_mul_f32 v[196:197], v[228:229], v[108:109]
    v_pk_mul_f32 v[198:199], v[230:231], v[110:111]
    v_cvt_pk_bf16_f32 v148, v192, v193
    v_cvt_pk_bf16_f32 v149, v194, v195
    v_cvt_pk_bf16_f32 v150, v196, v197
    v_cvt_pk_bf16_f32 v151, v198, v199
    buffer_store_dwordx4 v[148:151], v17, s[32:35], 0 offen offset:1024 sc1
    v_pk_fma_f32 v[192:193], v[112:113], s[4:5], v[4:5]
    v_pk_fma_f32 v[194:195], v[114:115], s[4:5], v[4:5]
    v_pk_fma_f32 v[196:197], v[116:117], s[4:5], v[4:5]
    v_pk_fma_f32 v[198:199], v[118:119], s[4:5], v[4:5]
    v_exp_f32 v192, v192 clamp
    v_exp_f32 v193, v193 clamp
    v_exp_f32 v194, v194 clamp
    v_exp_f32 v195, v195 clamp
    v_exp_f32 v196, v196 clamp
    v_exp_f32 v197, v197 clamp
    v_exp_f32 v198, v198 clamp
    v_exp_f32 v199, v199 clamp
    v_pk_add_f32 v[200:201], v[192:193], s[6:7]
    v_pk_add_f32 v[202:203], v[194:195], s[6:7]
    v_pk_add_f32 v[204:205], v[196:197], s[6:7]
    v_pk_add_f32 v[206:207], v[198:199], s[6:7]
    v_pk_fma_f32 v[224:225], v[192:193], v[200:201], s[8:9]
    v_pk_fma_f32 v[226:227], v[194:195], v[202:203], s[8:9]
    v_pk_fma_f32 v[228:229], v[196:197], v[204:205], s[8:9]
    v_pk_fma_f32 v[230:231], v[198:199], v[206:207], s[8:9]
    v_rcp_f32 v224, v224
    v_rcp_f32 v225, v225
    v_rcp_f32 v226, v226
    v_rcp_f32 v227, v227
    v_rcp_f32 v228, v228
    v_rcp_f32 v229, v229
    v_rcp_f32 v230, v230
    v_rcp_f32 v231, v231
    v_pk_mul_f32 v[224:225], v[224:225], v[192:193]
    v_pk_mul_f32 v[226:227], v[226:227], v[194:195]
    v_pk_mul_f32 v[228:229], v[228:229], v[196:197]
    v_pk_mul_f32 v[230:231], v[230:231], v[198:199]
    v_pk_mul_f32 v[224:225], v[224:225], v[200:201]
    v_pk_mul_f32 v[226:227], v[226:227], v[202:203]
    v_pk_mul_f32 v[228:229], v[228:229], v[204:205]
    v_pk_mul_f32 v[230:231], v[230:231], v[206:207]
    v_pk_mul_f32 v[192:193], v[224:225], v[112:113]
    v_pk_mul_f32 v[194:195], v[226:227], v[114:115]
    v_pk_mul_f32 v[196:197], v[228:229], v[116:117]
    v_pk_mul_f32 v[198:199], v[230:231], v[118:119]
    v_cvt_pk_bf16_f32 v152, v192, v193
    v_cvt_pk_bf16_f32 v153, v194, v195
    v_cvt_pk_bf16_f32 v154, v196, v197
    v_cvt_pk_bf16_f32 v155, v198, v199
    buffer_store_dwordx4 v[152:155], v17, s[32:35], 0 offen offset:2048 sc1
    s_cbranch_scc1 L_fskip
    s_mov_b64 exec, 0xff
    s_waitcnt vmcnt(3)
    global_store_dwordx4 v24, v[20:23], s[62:63] offset:1024 sc1
    s_mov_b64 exec, -1
L_fskip:
    v_pk_fma_f32 v[192:193], v[120:121], s[4:5], v[4:5]
    v_pk_fma_f32 v[194:195], v[122:123], s[4:5], v[4:5]
    v_pk_fma_f32 v[196:197], v[124:125], s[4:5], v[4:5]
    v_pk_fma_f32 v[198:199], v[126:127], s[4:5], v[4:5]
    v_exp_f32 v192, v192 clamp
    v_exp_f32 v193, v193 clamp
    v_exp_f32 v194, v194 clamp
    v_exp_f32 v195, v195 clamp
    v_exp_f32 v196, v196 clamp
    v_exp_f32 v197, v197 clamp
    v_exp_f32 v198, v198 clamp
    v_exp_f32 v199, v199 clamp
    v_pk_add_f32 v[200:201], v[192:193], s[6:7]
    v_pk_add_f32 v[202:203], v[194:195], s[6:7]
    v_pk_add_f32 v[204:205], v[196:197], s[6:7]
    v_pk_add_f32 v[206:207], v[198:199], s[6:7]
    v_pk_fma_f32 v[224:225], v[192:193], v[200:201], s[8:9]
    v_pk_fma_f32 v[226:227], v[194:195], v[202:203], s[8:9]
    v_pk_fma_f32 v[228:229], v[196:197], v[204:205], s[8:9]
    v_pk_fma_f32 v[230:231], v[198:199], v[206:207], s[8:9]
    v_rcp_f32 v224, v224
    v_rcp_f32 v225, v225
    v_rcp_f32 v226, v226
    v_rcp_f32 v227, v227
    v_rcp_f32 v228, v228
    v_rcp_f32 v229, v229
    v_rcp_f32 v230, v230
    v_rcp_f32 v231, v231
    v_pk_mul_f32 v[224:225], v[224:225], v[192:193]
    v_pk_mul_f32 v[226:227], v[226:227], v[194:195]
    v_pk_mul_f32 v[228:229], v[228:229], v[196:197]
    v_pk_mul_f32 v[230:231], v[230:231], v[198:199]
    v_pk_mul_f32 v[224:225], v[224:225], v[200:201]
    v_pk_mul_f32 v[226:227], v[226:227], v[202:203]
    v_pk_mul_f32 v[228:229], v[228:229], v[204:205]
    v_pk_mul_f32 v[230:231], v[230:231], v[206:207]
    v_pk_mul_f32 v[192:193], v[224:225], v[120:121]
    v_pk_mul_f32 v[194:195], v[226:227], v[122:123]
    v_pk_mul_f32 v[196:197], v[228:229], v[124:125]
    v_pk_mul_f32 v[198:199], v[230:231], v[126:127]
    v_cvt_pk_bf16_f32 v156, v192, v193
    v_cvt_pk_bf16_f32 v157, v194, v195
    v_cvt_pk_bf16_f32 v158, v196, v197
    v_cvt_pk_bf16_f32 v159, v198, v199
    buffer_store_dwordx4 v[156:159], v17, s[32:35], 0 offen offset:3072 sc1
    s_cbranch_scc1 L_dryx
    s_barrier
    s_mov_b64 exec, 0xff
    s_waitcnt vmcnt(0)
    global_store_dwordx4 v26, v[20:23], s[62:63] offset:1024 sc1
    s_mov_b64 exec, -1
    s_lshr_b32 s54, s2, 3
    s_or_b32 s54, s54, s45
    s_or_b32 s54, s54, s49
    s_cmp_lg_u32 s54, 0
    s_cbranch_scc1 L_final
    v_lshlrev_b32 v19, 3, v2
    s_mov_b32 s58, 0
L_poll2:
    global_load_dwordx2 v[28:29], v19, s[62:63] offset:512 sc1
    s_add_u32 s58, s58, 1
    s_waitcnt vmcnt(0)
    v_cmp_ne_u64 vcc, s[52:53], v[28:29]
    s_cmp_ge_u32 s58, 0x400000
    s_cbranch_scc1 L_poll2x
    s_cbranch_vccnz L_poll2
L_poll2x:
    s_mov_b64 exec, 1
    v_mov_b32 v19, 0
    global_store_dwordx2 v19, v[20:21], s[62:63] sc1
    s_mov_b64 exec, -1
    s_branch L_final
L_fin:
L_end:
    s_endpgm
.section .rodata,"a"
.p2align 6
.amdhsa_kernel standalone__dense_activation_mish__prompt_kernel
  .amdhsa_next_free_vgpr 256
  .amdhsa_next_free_sgpr 102
  .amdhsa_accum_offset 256
  .amdhsa_group_segment_fixed_size 0
  .amdhsa_kernarg_size 56
  .amdhsa_user_sgpr_count 2
  .amdhsa_user_sgpr_kernarg_segment_ptr 1
  .amdhsa_system_sgpr_workgroup_id_x 1
.end_amdhsa_kernel
```
